```python
import torch

def _softmax(x, axis=-1):
    return torch.softmax(x, dim=axis)
def _gelu(x):
    return torch.nn.functional.gelu(x, approximate="tanh")
def _silu(x):
    return torch.nn.functional.silu(x)
def _sigmoid(x):
    return torch.sigmoid(x)
def _layernorm(x, axis=-1, eps=1e-5):
    m = x.mean(dim=axis, keepdim=True)
    v = x.var(dim=axis, keepdim=True, unbiased=False)
    return (x - m) / torch.sqrt(v + eps)
def _scatter_add(tgt, idx, src, axis=0):
    return tgt.clone().index_add_(axis, idx, src)
def _segment_sum(src, seg, n):
    out = torch.zeros((n,) + src.shape[1:], dtype=src.dtype)
    return out.index_add_(0, seg, src)
def _pad(x, pw):
    flat = tuple(v for pair in reversed(pw) for v in pair)
    return torch.nn.functional.pad(x, flat)

kernel_name = 'gated_mix__sliding_block__dense_activation_mish__prompt'

def setup_inputs():

    _w = (lambda a: (lambda t: t.to(torch.bfloat16) if t.is_floating_point() else t)(torch.as_tensor(a)))
    def _A_setup():
        B, S, D = 1, 2048, 512
        return {
            "x": _w((lambda *s: torch.randn(*s, dtype=torch.bfloat16) * 0.05)(B, S, D)),
            "wqkv": _w((lambda *s: torch.randn(*s, dtype=torch.bfloat16) * 0.8)(D, 3 * D)),
            "wo": _w((lambda *s: torch.randn(*s, dtype=torch.bfloat16) * 0.05)(D, D)),
        }
    _A_in = _A_setup()

    def _B_setup():
        B, S, D, F = 1, 2048, 512, 1376
        return {
            "x": _w((lambda *s: torch.randn(*s, dtype=torch.bfloat16) * 0.05)(B, S, D)),
            "w1": _w((lambda *s: torch.randn(*s, dtype=torch.bfloat16) * 12.8)(D, F) * (D ** -0.5)),
            "b1": _w((lambda *s: torch.randn(*s, dtype=torch.bfloat16) * 0.8)(F)),
            "w2": _w((lambda *s: torch.randn(*s, dtype=torch.bfloat16) * 0.8)(F, D) * (F ** -0.5)),
        }
    _B_in = _B_setup()

    return {
        "A_x": _A_in["x"],
        "A_wqkv": _A_in["wqkv"],
        "A_wo": _A_in["wo"],
        "B_x": _B_in["x"],
        "B_w1": _B_in["w1"],
        "B_b1": _B_in["b1"],
        "B_w2": _B_in["w2"],
        "gate_w": _w((lambda *s: torch.randn(*s, dtype=torch.bfloat16) * 0.05)(512) * 16.0),
    }

def reference(A_x, A_wqkv, A_wo, B_x, B_w1, B_b1, B_w2, gate_w):
    def _A_ref(x, wqkv, wo):
        B, S, D = x.shape
        H = 32; Dh = D // H; W = 256
        qkv = (lambda x, *d: x.permute(*d))((x @ wqkv).reshape(B, S, 3, H, Dh), 2, 0, 3, 1, 4)
        q, k, v = qkv[0], qkv[1], qkv[2]
        scores = torch.einsum("bhqd,bhkd->bhqk", q, k) * (Dh ** -0.5)
        idx = torch.arange(S)
        mask = (idx[:, None] - idx[None, :] >= 0) & (idx[:, None] - idx[None, :] < W)
        scores = torch.where(mask[None, None], scores, -1e9)
        p = _softmax(scores, axis=-1)
        o = torch.einsum("bhqk,bhkd->bhqd", p, v)
        return (lambda x, *d: x.permute(*d))(o, 0, 2, 1, 3).reshape(B, S, D) @ wo

    def _B_ref(x, w1, b1, w2):
        h = torch.einsum("bsd,df->bsf", x, w1) + b1
        sp = torch.log1p(torch.exp(-torch.abs(h))) + torch.where(h > 0, h, torch.zeros_like(h))
        act = h * torch.tanh(sp)
        return torch.einsum("bsf,fd->bsd", act, w2)

    x = A_x
    g = _sigmoid((x * gate_w).sum(-1, keepdims=True))
    a = _A_ref(x, A_wqkv, A_wo)
    b = _B_ref(x, B_w1, B_b1, B_w2)
    return g * a + (1 - g) * b
```

```asm
; @launch grid=(256,1,1) block=(256,1,1) lds=163840
.amdgcn_target "amdgcn-amd-amdhsa--gfx950"
.text
.globl gated_mix__sliding_block__dense_activation_mish__prompt_kernel
.p2align 8
.type gated_mix__sliding_block__dense_activation_mish__prompt_kernel,@function
gated_mix__sliding_block__dense_activation_mish__prompt_kernel:
    s_cmp_ge_u32 s2, 256
    s_cbranch_scc1 END
    s_nop 0
    s_load_dwordx2 s[4:5], s[0:1], 0
    s_load_dwordx2 s[8:9], s[0:1], 8
    s_load_dwordx2 s[16:17], s[0:1], 32
    s_load_dwordx2 s[36:37], s[0:1], 80
    s_load_dwordx2 s[20:21], s[0:1], 40
    s_load_dwordx2 s[12:13], s[0:1], 16
    s_load_dwordx2 s[24:25], s[0:1], 48
    s_load_dwordx2 s[28:29], s[0:1], 56
    s_load_dwordx2 s[32:33], s[0:1], 64
    s_load_dwordx2 s[40:41], s[0:1], 72
    s_getpc_b64 s[60:61]
    s_lshr_b32 s43, s2, 3
    s_lshl_b32 s54, s43, 10
    v_lshrrev_b32 v1, 5, v0
    v_lshlrev_b32 v1, 7, v1
    v_add_u32 v1, s54, v1
    v_min_u32 v1, CODE_BYTES, v1
    global_load_dword a251, v1, s[60:61]
    v_lshrrev_b32_e64 v1, 6, v0
    v_and_b32 v0, 63, v0
    v_readfirstlane_b32 s3, v1
    s_and_b32 s42, s2, 7
    s_lshr_b32 s44, s42, 2
    s_lshl_b32 s44, s44, 3
    s_lshr_b32 s58, s43, 2
    s_add_u32 s44, s44, s58
    s_and_b32 s45, s42, 3
    s_lshl_b32 s45, s45, 2
    s_and_b32 s57, s43, 3
    s_add_u32 s45, s45, s57
    s_lshl_b32 s46, s45, 1
    s_min_u32 s54, s45, 11
    s_add_u32 s46, s46, s54
    s_cmp_lt_u32 s45, 11
    s_cselect_b32 s47, 3, 2
    s_lshl_b32 s57, s57, 1
    s_add_u32 s57, s57, s58
    s_and_b32 s63, s57, 7
    s_mov_b32 s64, s63
    s_lshl_b32 s48, s44, 2
    s_add_u32 s48, s48, s3
    s_lshl_b32 s54, s48, 15
    v_lshrrev_b32 v21, 3, v0
    v_and_b32 v22, 7, v0
    v_lshrrev_b32 v23, 4, v0
    v_xor_b32 v1, v22, v23
    v_lshlrev_b32 v1, 4, v1
    v_lshl_add_u32 v1, v21, 10, v1
    v_add_u32 v1, s54, v1
    v_xor_b32 v2, 64, v1
    v_add_u32 v2, 7168, v2
    v_add_u32 v3, 14336, v1
    v_add_u32 v4, 14336, v2
    v_and_b32 v23, 1, v23
    v_lshlrev_b32 v23, 2, v23
    v_xor_b32 v22, v22, v23
    v_lshlrev_b32 v22, 4, v22
    v_lshl_add_u32 v192, v21, 10, v22
    s_lshl_b32 s54, s3, 4
    v_add_u32 v21, s54, v21
    v_mul_u32_u24 v5, 3072, v21
    s_lshl_b32 s55, s45, 7
    s_add_u32 s55, s55, 1024
    v_add3_u32 v5, v5, v22, s55
    v_add_u32 v6, 23552, v5
    s_lshl_b32 s59, s3, 12
    s_mov_b32 s6, 2097152
    s_mov_b32 s7, 0x20000
    s_mov_b32 s10, 1572864
    s_mov_b32 s11, 0x20000
    s_mov_b32 s18, 1409024
    s_mov_b32 s19, 0x20000
    s_lshl_b32 s60, s3, 11
    s_add_u32 s60, s60, 81920
    s_lshl_b32 s61, s3, 10
    s_add_u32 s61, s61, 49152
    s_mul_i32 s62, s3, 3072
    s_add_u32 s62, s62, 90112
    s_waitcnt lgkmcnt(0)
    s_mov_b32 s0, s63
    s_add_u32 m0, s59, 0
    s_lshl_b32 s1, s63, 7
    buffer_load_dwordx4 v1, s[4:7], s1 offen offset:0 lds
    buffer_load_dwordx4 v2, s[4:7], s1 offen offset:1024 lds
    buffer_load_dwordx4 v3, s[4:7], s1 offen offset:2048 lds
    buffer_load_dwordx4 v4, s[4:7], s1 offen offset:3072 lds
    s_add_u32 m0, s60, 0
    s_mul_i32 s1, s63, 196608
    buffer_load_dwordx4 v5, s[8:11], s1 offen offset:0 lds
    buffer_load_dwordx4 v6, s[8:11], s1 offen offset:1024 lds
    s_add_u32 s63, s63, 1
    s_and_b32 s63, s63, 7
    s_mul_i32 s56, s3, 192
    s_lshl_b32 s55, s46, 6
    s_lshl_b32 s58, s47, 2
    v_mov_b32 v24, 0x40000000
    v_add_u32 v21, s56, v0
    v_add_u32 v21, 0, v21
    v_mul_u32_u24 v22, 43691, v21
    v_lshrrev_b32 v22, 19, v22
    v_mul_u32_u24 v23, 12, v22
    v_sub_u32_e64 v23, v21, v23
    v_mul_u32_u24 v22, 2752, v22
    v_lshl_add_u32 v22, v23, 4, v22
    v_add_u32_e64 v22, s55, v22
    v_cmp_gt_u32 vcc, s58, v23
    v_subrev_u32 v22, 0, v22
    s_nop 0
    v_cndmask_b32 v7, v24, v22, vcc
    v_add_u32 v21, s56, v0
    v_add_u32 v21, 64, v21
    v_mul_u32_u24 v22, 43691, v21
    v_lshrrev_b32 v22, 19, v22
    v_mul_u32_u24 v23, 12, v22
    v_sub_u32_e64 v23, v21, v23
    v_mul_u32_u24 v22, 2752, v22
    v_lshl_add_u32 v22, v23, 4, v22
    v_add_u32 v22, s55, v22
    v_cmp_gt_u32 vcc, s58, v23
    v_subrev_u32 v22, 1024, v22
    s_nop 0
    v_cndmask_b32 v8, v24, v22, vcc
    v_add_u32_e64 v21, s56, v0
    v_add_u32 v21, 128, v21
    v_mul_u32_u24 v22, 43691, v21
    v_lshrrev_b32 v22, 19, v22
    v_mul_u32_u24 v23, 12, v22
    v_sub_u32_e64 v23, v21, v23
    v_mul_u32_u24 v22, 2752, v22
    v_lshl_add_u32 v22, v23, 4, v22
    v_add_u32_e64 v22, s55, v22
    v_cmp_gt_u32 vcc, s58, v23
    v_subrev_u32 v22, 2048, v22
    s_nop 0
    v_cndmask_b32 v9, v24, v22, vcc
    s_add_u32 m0, s62, 0
    s_mul_i32 s1, s0, 176128
    buffer_load_dwordx4 v7, s[16:19], s1 offen offset:0 lds
    buffer_load_dwordx4 v8, s[16:19], s1 offen offset:1024 lds
    buffer_load_dwordx4 v9, s[16:19], s1 offen offset:2048 lds
    s_add_u32 s0, s0, 1
    s_and_b32 s0, s0, 7
    v_lshrrev_b32 v21, 2, v0
    v_add_u32 v21, s54, v21
    v_and_b32 v22, 3, v0
    v_lshlrev_b32 v22, 4, v22
    v_mul_u32_u24 v10, 3072, v21
    s_lshl_b32 s56, s45, 6
    v_add3_u32 v10, v10, v22, s56
    s_add_u32 m0, s61, 0
    s_mul_i32 s1, s64, 196608
    buffer_load_dwordx4 v10, s[8:11], s1 offen lds
    s_add_u32 s64, s64, 1
    s_and_b32 s64, s64, 7
    s_mov_b32 s38, 16777216
    s_mov_b32 s39, 0x20000
    s_mov_b32 s22, 2752
    s_mov_b32 s23, 0x20000
    s_mov_b32 s14, 524288
    s_mov_b32 s15, 0x20000
    s_mov_b32 s26, 1409024
    s_mov_b32 s27, 0x20000
    s_mov_b32 s30, 1024
    s_mov_b32 s31, 0x20000
    s_mov_b32 s34, 2097152
    s_mov_b32 s35, 0x20000
    v_lshlrev_b32 v60, 4, v0
    v_mov_b32 v63, 0
    v_mov_b32 v206, 1
    s_or_b32 s54, s2, s3
    s_cmp_eq_u32 s54, 0
    s_cbranch_scc1 CLR
NOCLR:
    s_lshl_b32 s55, s46, 6
    v_lshlrev_b32 v21, 1, v0
    buffer_load_ushort v160, v21, s[20:23], s55 offen
    buffer_load_ushort v164, v21, s[20:23], s55 offen offset:128
    buffer_load_dwordx4 v[96:99], v60, s[28:31], 0 offen
    s_lshr_b32 s56, s3, 1
    s_and_b32 s57, s3, 1
    s_lshl_b32 s49, s44, 1
    s_add_u32 s49, s49, s56
    s_lshl_b32 s50, s45, 1
    s_add_u32 s50, s50, s57
    s_lshr_b32 s51, s42, 1
    s_lshl_b32 s51, s51, 3
    s_lshr_b32 s54, s43, 2
    s_add_u32 s51, s51, s54
    s_and_b32 s52, s42, 1
    s_lshl_b32 s52, s52, 2
    s_and_b32 s54, s43, 3
    s_add_u32 s52, s52, s54
    s_mul_i32 s54, s3, 22
    s_cmp_eq_u32 s3, 3
    s_cselect_b32 s53, 65, s54
    s_lshl_b32 s65, s45, 18
    s_lshl_b32 s54, s48, 10
    s_add_u32 s65, s65, s54
    s_add_u32 s65, s65, 2097152
    s_movk_i32 s54, 512
    s_cmp_ge_u32 s45, 8
    s_cselect_b32 s66, s54, 65536
    s_cselect_b64 vcc, -1, 0
    s_and_b32 s67, s45, 7
    s_lshl_b32 s67, s67, 4
    s_add_u32 s67, s67, s44
    s_lshl_b32 s67, s67, 7
    s_add_u32 s67, s67, 15728640
    s_lshr_b32 s68, s45, 1
    s_lshl_b32 s68, s68, 4
    s_add_u32 s68, s68, s44
    s_lshl_b32 s68, s68, 7
    s_add_u32 s68, s68, 15728640
    s_lshl_b32 s69, s50, 16
    s_lshl_b32 s54, s49, 11
    s_add_u32 s69, s69, s54
    s_add_u32 s69, s69, 2088960
    s_lshl_b32 s54, s49, 6
    s_lshl_b32 s55, s50, 1
    s_add_u32 s54, s54, s55
    s_lshl_b32 s70, s54, 10
    s_lshl_b32 s71, s54, 2
    s_add_u32 s71, s71, 14680064
    s_mul_i32 s72, s48, 88064
    s_lshl_b32 s54, s46, 11
    s_add_u32 s72, s72, s54
    s_add_u32 s72, s72, 8388608
    s_add_u32 s73, s72, 4096
    s_cmp_eq_u32 s47, 3
    s_cselect_b32 s73, s73, 0x40000000
    s_lshl_b32 s54, s49, 7
    s_add_u32 s74, s54, 15745024
    s_add_u32 s78, s54, 15749120
    s_lshl_b32 s54, s51, 7
    s_add_u32 s75, s54, 15745024
    s_add_u32 s79, s54, 15749120
    s_mul_i32 s76, s51, 172
    s_add_u32 s76, s76, s53
    s_lshl_b32 s76, s76, 10
    s_add_u32 s76, s76, 8388608
    s_lshl_b32 s77, s49, 16
    s_lshl_b32 s54, s50, 10
    s_add_u32 s77, s77, s54
    s_add_u32 s77, s77, 6291456
    s_lshl_b32 s80, s51, 16
    s_lshl_b32 s54, s3, 13
    s_add_u32 s80, s80, s54
    s_add_u32 s80, s80, 6291456
    s_lshl_b32 s81, s51, 8
    s_lshl_b32 s54, s57, 7
    s_add_u32 s81, s81, s54
    s_add_u32 s81, s81, 14680064
    s_lshl_b32 s82, s57, 15
    s_lshl_b32 s54, s51, 16
    s_add_u32 s82, s82, s54
    s_lshl_b32 s54, s56, 6
    s_add_u32 s82, s82, s54
    s_lshl_b32 s54, s52, 7
    s_add_u32 s82, s82, s54
    s_lshl_b32 s83, s53, 14
    s_add_u32 s83, s83, s54
    s_lshl_b32 s84, s3, 17
    s_add_u32 s84, s84, s54
    s_mov_b32 s85, 0xffff
    s_and_b32 s86, s42, 1
    s_lshl_b32 s86, s86, 9
    s_lshl_b32 s58, s43, 2
    s_add_u32 s58, s58, s3
    s_lshl_b32 s87, s58, 12
    s_add_u32 s87, s87, s86
    s_mul_i32 s58, s58, 43
    s_or_b32 s42, s2, s3
    s_and_b32 s54, s43, 3
    s_lshl_b32 s54, s54, 2
    s_add_u32 s54, s54, s3
    s_mul_i32 s54, s54, 11008
    s_mul_i32 s48, s51, 176128
    s_add_u32 s48, s48, s54
    s_add_u32 s48, s48, 8388608
    s_min_u32 s54, s44, 1
    s_lshl_b32 s54, s54, 7
    s_sub_u32 s51, s68, s54
    s_min_u32 s54, s44, 2
    s_lshl_b32 s54, s54, 7
    s_sub_u32 s52, s68, s54
    s_mov_b32 s53, 1
    v_lshrrev_b32 v22, 5, v0
    v_and_b32 v61, 15, v0
    v_lshlrev_b32 v61, 4, v61
    v_lshl_add_u32 v61, v22, 8, v61
    v_bfe_u32 v21, v0, 4, 1
    v_lshl_add_u32 v21, v21, 16, v61
    v_cndmask_b32 v202, v60, v21, vcc
    v_and_b32 v62, 31, v0
    v_lshlrev_b32 v62, 2, v62
    v_min_u32 v204, 42, v0
    v_add_u32 v204, s58, v204
    v_lshrrev_b32 v21, 2, v204
    v_and_b32 v204, 3, v204
    v_lshlrev_b32 v204, 7, v204
    v_lshl_add_u32 v204, v21, 10, v204
    v_bfe_u32 v21, v0, 2, 2
    v_and_b32 v205, 3, v0
    v_lshlrev_b32 v205, 7, v205
    v_lshl_add_u32 v205, v21, 10, v205
    s_mul_i32 s54, s57, 88064
    v_add_u32_e64 v198, s54, v60
    s_sub_u32 s54, 88064, s54
    v_add_u32_e64 v199, s54, v60
    s_lshl_b32 s54, s57, 15
    v_add_u32 v200, s54, v60
    v_xor_b32 v201, 0x8000, v200
    v_add_u32 v193, 7168, v192
    v_add_u32 v194, 14336, v192
    v_add_u32 v195, 21504, v192
    v_and_b32 v21, 31, v0
    v_lshrrev_b32 v22, 5, v0
    v_bfe_u32 v23, v0, 1, 3
    v_xor_b32 v23, v23, v22
    v_lshlrev_b32 v23, 4, v23
    v_lshl_add_u32 v11, v21, 7, v23
    v_add_u32 v11, s59, v11
    v_xor_b32 v12, 32, v11
    v_xor_b32_e64 v13, 64, v11
    v_xor_b32 v14, 96, v11
    v_bfe_u32 v21, v0, 4, 1
    v_lshlrev_b32 v21, 5, v21
    v_and_b32 v23, 3, v0
    v_lshl_add_u32 v21, v23, 3, v21
    v_bfe_u32 v23, v0, 2, 2
    v_bfe_u32 v24, v0, 3, 1
    v_lshl_add_u32 v24, v24, 6, v21
    v_lshl_add_u32 v196, v22, 2, v23
    v_lshl_add_u32 v196, v196, 7, v24
    v_add_u32 v196, s59, v196
    s_lshl_b32 s54, s56, 6
    v_xor_b32 v196, s54, v196
    v_xor_b32 v197, 64, v196
    v_lshl_add_u32 v23, v22, 3, v23
    v_lshl_add_u32 v15, v23, 7, v24
    v_add_u32 v15, 81920, v15
    v_xor_b32_e64 v16, 64, v15
    v_add_u32 v17, 40960, v15
    v_add_u32 v18, 40960, v16
    v_lshl_add_u32 v26, v23, 6, v21
    v_add_u32 v26, 49152, v26
    v_mul_u32_u24 v19, 192, v23
    v_add_u32_e64 v19, v19, v21
    v_add_u32 v19, 90112, v19
    v_add_u32 v20, 40960, v19
    s_mov_b32 s54, 0x3f803f80
    v_accvgpr_write_b32 a168, s54
    v_accvgpr_write_b32 a169, s54
    v_accvgpr_write_b32 a170, s54
    v_accvgpr_write_b32 a171, s54
    v_accvgpr_write_b32 a172, s54
    v_accvgpr_write_b32 a173, s54
    v_accvgpr_write_b32 a174, s54
    v_accvgpr_write_b32 a175, s54
    v_accvgpr_write_b32 a176, s54
    v_accvgpr_write_b32 a177, s54
    v_accvgpr_write_b32 a178, s54
    v_accvgpr_write_b32 a179, s54
    v_accvgpr_write_b32 a180, s54
    v_accvgpr_write_b32 a181, s54
    v_accvgpr_write_b32 a182, s54
    v_accvgpr_write_b32 a183, s54
    v_accvgpr_write_b32 a184, s54
    v_accvgpr_write_b32 a185, s54
    v_accvgpr_write_b32 a186, s54
    v_accvgpr_write_b32 a187, s54
    v_accvgpr_write_b32 a188, s54
    v_accvgpr_write_b32 a189, s54
    v_accvgpr_write_b32 a190, s54
    v_accvgpr_write_b32 a191, s54
    v_accvgpr_write_b32 a192, s54
    v_accvgpr_write_b32 a193, s54
    v_accvgpr_write_b32 a194, s54
    v_accvgpr_write_b32 a195, s54
    v_accvgpr_write_b32 a196, s54
    v_accvgpr_write_b32 a197, s54
    v_accvgpr_write_b32 a198, s54
    v_accvgpr_write_b32 a199, s54
    v_accvgpr_write_b32 a200, s54
    v_accvgpr_write_b32 a201, s54
    v_accvgpr_write_b32 a202, s54
    v_accvgpr_write_b32 a203, s54
    v_accvgpr_write_b32 a204, s54
    v_accvgpr_write_b32 a205, s54
    v_accvgpr_write_b32 a206, s54
    v_accvgpr_write_b32 a207, s54
    v_accvgpr_write_b32 a208, s54
    v_accvgpr_write_b32 a209, s54
    v_accvgpr_write_b32 a210, s54
    v_accvgpr_write_b32 a211, s54
    v_accvgpr_write_b32 a212, s54
    v_accvgpr_write_b32 a213, s54
    v_accvgpr_write_b32 a214, s54
    v_accvgpr_write_b32 a215, s54
    v_accvgpr_write_b32 a216, s54
    v_accvgpr_write_b32 a217, s54
    v_accvgpr_write_b32 a218, s54
    v_accvgpr_write_b32 a219, s54
    v_accvgpr_write_b32 a220, s54
    v_accvgpr_write_b32 a221, s54
    v_accvgpr_write_b32 a222, s54
    v_accvgpr_write_b32 a223, s54
    v_accvgpr_write_b32 a224, s54
    v_accvgpr_write_b32 a225, s54
    v_accvgpr_write_b32 a226, s54
    v_accvgpr_write_b32 a227, s54
    v_accvgpr_write_b32 a228, s54
    v_accvgpr_write_b32 a229, s54
    v_accvgpr_write_b32 a230, s54
    v_accvgpr_write_b32 a231, s54
    v_accvgpr_write_b32 a232, s54
    v_accvgpr_write_b32 a233, s54
    v_accvgpr_write_b32 a234, s54
    v_accvgpr_write_b32 a235, s54
    v_accvgpr_write_b32 a236, s54
    v_accvgpr_write_b32 a237, s54
    v_accvgpr_write_b32 a238, s54
    v_accvgpr_write_b32 a239, s54
    v_accvgpr_write_b32 a240, s54
    v_accvgpr_write_b32 a241, s54
    v_accvgpr_write_b32 a242, s54
    v_accvgpr_write_b32 a243, s54
    v_accvgpr_write_b32 a244, s54
    v_accvgpr_write_b32 a245, s54
    v_accvgpr_write_b32 a246, s54
    v_accvgpr_write_b32 a247, s54
    v_and_b32 v24, 31, v0
    v_lshlrev_b32 v23, 2, v22
    v_sub_u32 v24, v24, v23
    v_mov_b32 v25, 0xf149f2ca
    s_cmp_lt_u32 s49, 4
    s_cselect_b32 s54, 0xf149f2ca, 0
    v_mov_b32 v180, s54
    v_cmp_le_i32 vcc, 0, v24
    v_mov_b32 v208, 0
    v_mov_b32 v175, 0
    v_cndmask_b32_e64 v224, v25, 0, vcc
    v_cndmask_b32_e64 v240, v180, v25, vcc
    v_cmp_le_i32 vcc, 1, v24
    v_mov_b32 v209, 0
    v_mov_b32_e64 v174, 0
    v_cndmask_b32_e64 v225, v25, 0, vcc
    v_cndmask_b32_e64 v241, v180, v25, vcc
    v_cmp_le_i32 vcc, 2, v24
    v_mov_b32 v210, 0
    v_mov_b32_e64 v173, 0
    v_cndmask_b32_e64 v226, v25, 0, vcc
    v_cndmask_b32_e64 v242, v180, v25, vcc
    v_cmp_le_i32 vcc, 3, v24
    v_mov_b32 v211, 0
    v_mov_b32_e64 v171, 0
    v_cndmask_b32_e64 v227, v25, 0, vcc
    v_cndmask_b32_e64 v243, v180, v25, vcc
    v_cmp_le_i32 vcc, 8, v24
    v_mov_b32 v212, 0
    v_mov_b32_e64 v170, 0
    v_cndmask_b32_e64 v228, v25, 0, vcc
    v_cndmask_b32_e64 v244, v180, v25, vcc
    v_cmp_le_i32 vcc, 9, v24
    v_mov_b32 v213, 0
    v_mov_b32_e64 v169, 0
    v_cndmask_b32_e64 v229, v25, 0, vcc
    v_cndmask_b32_e64 v245, v180, v25, vcc
    v_cmp_le_i32 vcc, 10, v24
    v_mov_b32 v214, 0
    v_mov_b32_e64 v167, 0
    v_cndmask_b32_e64 v230, v25, 0, vcc
    v_cndmask_b32_e64 v246, v180, v25, vcc
    v_cmp_le_i32 vcc, 11, v24
    v_mov_b32 v215, 0
    v_mov_b32_e64 v166, 0
    v_cndmask_b32_e64 v231, v25, 0, vcc
    v_cndmask_b32_e64 v247, v180, v25, vcc
    v_cmp_le_i32 vcc, 16, v24
    v_mov_b32 v216, 0
    v_mov_b32_e64 v165, 0
    v_cndmask_b32_e64 v232, v25, 0, vcc
    v_cndmask_b32_e64 v248, v180, v25, vcc
    v_cmp_le_i32 vcc, 17, v24
    v_mov_b32 v217, 0
    v_mov_b32_e64 v163, 0
    v_cndmask_b32_e64 v233, v25, 0, vcc
    v_cndmask_b32_e64 v249, v180, v25, vcc
    v_cmp_le_i32 vcc, 18, v24
    v_mov_b32 v218, 0
    v_mov_b32_e64 v162, 0
    v_cndmask_b32_e64 v234, v25, 0, vcc
    v_cndmask_b32_e64 v250, v180, v25, vcc
    v_cmp_le_i32 vcc, 19, v24
    v_mov_b32 v219, 0
    v_mov_b32_e64 v161, 0
    v_cndmask_b32_e64 v235, v25, 0, vcc
    v_cndmask_b32_e64 v251, v180, v25, vcc
    v_cmp_le_i32 vcc, 24, v24
    v_mov_b32 v220, 0
    s_nop 0
    v_cndmask_b32_e64 v236, v25, 0, vcc
    v_cndmask_b32_e64 v252, v180, v25, vcc
    v_cmp_le_i32 vcc, 25, v24
    v_mov_b32 v221, 0
    s_nop 0
    v_cndmask_b32_e64 v237, v25, 0, vcc
    v_cndmask_b32_e64 v253, v180, v25, vcc
    v_cmp_le_i32 vcc, 26, v24
    v_mov_b32 v222, 0
    s_nop 0
    v_cndmask_b32_e64 v238, v25, 0, vcc
    v_cndmask_b32_e64 v254, v180, v25, vcc
    v_cmp_le_i32 vcc, 27, v24
    v_mov_b32 v223, 0
    s_nop 0
    v_cndmask_b32_e64 v239, v25, 0, vcc
    v_cndmask_b32_e64 v255, v180, v25, vcc
    v_cmp_gt_u32 vcc, 32, v0
    v_mov_b32 v21, 0x3f80
    s_nop 0
    v_cndmask_b32 v168, 0, v21, vcc
    v_cndmask_b32_e64 v172, v21, 0, vcc
    s_cmp_ge_u32 s45, 8
    s_cbranch_scc1 PA_V
    s_add_u32 m0, s59, 16384
    s_lshl_b32 s1, s63, 7
    buffer_load_dwordx4 v1, s[4:7], s1 offen offset:0 lds
    buffer_load_dwordx4 v2, s[4:7], s1 offen offset:1024 lds
    buffer_load_dwordx4 v3, s[4:7], s1 offen offset:2048 lds
    buffer_load_dwordx4 v4, s[4:7], s1 offen offset:3072 lds
    s_add_u32 m0, s60, 20480
    s_mul_i32 s1, s63, 196608
    buffer_load_dwordx4 v5, s[8:11], s1 offen offset:0 lds
    buffer_load_dwordx4 v6, s[8:11], s1 offen offset:1024 lds
    s_add_u32 s63, s63, 1
    s_and_b32 s63, s63, 7
    s_waitcnt vmcnt(6)
    s_cmp_eq_u32 s42, 0
    s_cbranch_scc1 GOK
NOGOK:
    s_barrier
    ds_read_b128 a[0:3], v11 offset:0
    ds_read_b64_tr_b16 v[28:29], v15 offset:0
    ds_read_b64_tr_b16 v[30:31], v15 offset:512
    ds_read_b64_tr_b16 v[32:33], v16 offset:0
    ds_read_b64_tr_b16 v[34:35], v16 offset:512
    ds_read_b128 a[4:7], v12 offset:0
    ds_read_b64_tr_b16 v[36:37], v15 offset:2048
    ds_read_b64_tr_b16 v[38:39], v15 offset:2560
    ds_read_b64_tr_b16 v[40:41], v16 offset:2048
    ds_read_b64_tr_b16 v[42:43], v16 offset:2560
    ds_read_b128 a[8:11], v13 offset:0
    ds_read_b64_tr_b16 v[44:45], v15 offset:4096
    ds_read_b64_tr_b16 v[46:47], v15 offset:4608
    v_mfma_f32_32x32x16_bf16 v[112:127], v[160:163], v[168:171], 0
    v_mfma_f32_32x32x16_bf16 v[128:143], v[160:163], v[172:175], 0
    v_mfma_f32_32x32x16_bf16 v[144:159], v[164:167], v[168:171], 0
    s_waitcnt lgkmcnt(10)
    v_mfma_f32_32x32x16_bf16 v[64:79], v[28:31], a[0:3], 0
    ds_read_b64_tr_b16 v[48:49], v16 offset:4096
    ds_read_b64_tr_b16 v[50:51], v16 offset:4608
    s_add_u32 m0, s59, 32768
    s_lshl_b32 s1, s63, 7
    buffer_load_dwordx4 v1, s[4:7], s1 offen offset:0 lds
    buffer_load_dwordx4 v2, s[4:7], s1 offen offset:1024 lds
    s_waitcnt lgkmcnt(10)
    v_mfma_f32_32x32x16_bf16 v[80:95], v[32:35], a[0:3], 0
    ds_read_b128 a[12:15], v14 offset:0
    ds_read_b64_tr_b16 v[52:53], v15 offset:6144
    ds_read_b64_tr_b16 v[54:55], v15 offset:6656
    buffer_load_dwordx4 v3, s[4:7], s1 offen offset:2048 lds
    buffer_load_dwordx4 v4, s[4:7], s1 offen offset:3072 lds
    s_waitcnt lgkmcnt(10)
    v_mfma_f32_32x32x16_bf16 v[64:79], v[36:39], a[4:7], v[64:79]
    ds_read_b64_tr_b16 v[56:57], v16 offset:6144
    ds_read_b64_tr_b16 v[58:59], v16 offset:6656
    s_add_u32 m0, s60, 40960
    s_mul_i32 s1, s63, 196608
    buffer_load_dwordx4 v5, s[8:11], s1 offen offset:0 lds
    buffer_load_dwordx4 v6, s[8:11], s1 offen offset:1024 lds
    s_add_u32 s63, s63, 1
    s_and_b32 s63, s63, 7
    s_waitcnt lgkmcnt(10)
    v_mfma_f32_32x32x16_bf16 v[80:95], v[40:43], a[4:7], v[80:95]
    s_waitcnt vmcnt(6)
    s_barrier
    ds_read_b128 a[16:19], v11 offset:16384
    ds_read_b64_tr_b16 v[28:29], v15 offset:20480
    ds_read_b64_tr_b16 v[30:31], v15 offset:20992
    s_waitcnt lgkmcnt(10)
    v_mfma_f32_32x32x16_bf16 v[64:79], v[44:47], a[8:11], v[64:79]
    ds_read_b64_tr_b16 v[32:33], v16 offset:20480
    ds_read_b64_tr_b16 v[34:35], v16 offset:20992
    s_waitcnt lgkmcnt(10)
    v_mfma_f32_32x32x16_bf16 v[80:95], v[48:51], a[8:11], v[80:95]
    ds_read_b128 a[20:23], v12 offset:16384
    ds_read_b64_tr_b16 v[36:37], v15 offset:22528
    ds_read_b64_tr_b16 v[38:39], v15 offset:23040
    s_waitcnt lgkmcnt(10)
    v_mfma_f32_32x32x16_bf16 v[64:79], v[52:55], a[12:15], v[64:79]
    ds_read_b64_tr_b16 v[40:41], v16 offset:22528
    ds_read_b64_tr_b16 v[42:43], v16 offset:23040
    s_add_u32 m0, s59, 0
    s_lshl_b32 s1, s63, 7
    buffer_load_dwordx4 v1, s[4:7], s1 offen offset:0 lds
    buffer_load_dwordx4 v2, s[4:7], s1 offen offset:1024 lds
    s_waitcnt lgkmcnt(10)
    v_mfma_f32_32x32x16_bf16 v[80:95], v[56:59], a[12:15], v[80:95]
    ds_read_b128 a[24:27], v13 offset:16384
    ds_read_b64_tr_b16 v[44:45], v15 offset:24576
    ds_read_b64_tr_b16 v[46:47], v15 offset:25088
    buffer_load_dwordx4 v3, s[4:7], s1 offen offset:2048 lds
    s_waitcnt lgkmcnt(10)
    v_mfma_f32_32x32x16_bf16 v[64:79], v[28:31], a[16:19], v[64:79]
    ds_read_b64_tr_b16 v[48:49], v16 offset:24576
    ds_read_b64_tr_b16 v[50:51], v16 offset:25088
    buffer_load_dwordx4 v4, s[4:7], s1 offen offset:3072 lds
    s_waitcnt lgkmcnt(10)
    v_mfma_f32_32x32x16_bf16 v[80:95], v[32:35], a[16:19], v[80:95]
    ds_read_b128 a[28:31], v14 offset:16384
    ds_read_b64_tr_b16 v[52:53], v15 offset:26624
    ds_read_b64_tr_b16 v[54:55], v15 offset:27136
    s_add_u32 m0, s60, 61440
    s_mul_i32 s1, s63, 196608
    buffer_load_dwordx4 v5, s[8:11], s1 offen offset:0 lds
    s_waitcnt lgkmcnt(10)
    v_mfma_f32_32x32x16_bf16 v[64:79], v[36:39], a[20:23], v[64:79]
    ds_read_b64_tr_b16 v[56:57], v16 offset:26624
    ds_read_b64_tr_b16 v[58:59], v16 offset:27136
    buffer_load_dwordx4 v6, s[8:11], s1 offen offset:1024 lds
    s_add_u32 s63, s63, 1
    s_and_b32 s63, s63, 7
    s_waitcnt lgkmcnt(10)
    v_mfma_f32_32x32x16_bf16 v[80:95], v[40:43], a[20:23], v[80:95]
    s_waitcnt vmcnt(6)
    s_barrier
    ds_read_b128 a[32:35], v11 offset:32768
    ds_read_b64_tr_b16 v[28:29], v17 offset:0
    ds_read_b64_tr_b16 v[30:31], v17 offset:512
    s_waitcnt lgkmcnt(10)
    v_mfma_f32_32x32x16_bf16 v[64:79], v[44:47], a[24:27], v[64:79]
    ds_read_b64_tr_b16 v[32:33], v18 offset:0
    ds_read_b64_tr_b16 v[34:35], v18 offset:512
    s_waitcnt lgkmcnt(10)
    v_mfma_f32_32x32x16_bf16 v[80:95], v[48:51], a[24:27], v[80:95]
    ds_read_b128 a[36:39], v12 offset:32768
    ds_read_b64_tr_b16 v[36:37], v17 offset:2048
    ds_read_b64_tr_b16 v[38:39], v17 offset:2560
    s_waitcnt lgkmcnt(10)
    v_mfma_f32_32x32x16_bf16 v[64:79], v[52:55], a[28:31], v[64:79]
    ds_read_b64_tr_b16 v[40:41], v18 offset:2048
    ds_read_b64_tr_b16 v[42:43], v18 offset:2560
    s_add_u32 m0, s59, 16384
    s_lshl_b32 s1, s63, 7
    buffer_load_dwordx4 v1, s[4:7], s1 offen offset:0 lds
    buffer_load_dwordx4 v2, s[4:7], s1 offen offset:1024 lds
    s_waitcnt lgkmcnt(10)
    v_mfma_f32_32x32x16_bf16 v[80:95], v[56:59], a[28:31], v[80:95]
    ds_read_b128 a[40:43], v13 offset:32768
    ds_read_b64_tr_b16 v[44:45], v17 offset:4096
    ds_read_b64_tr_b16 v[46:47], v17 offset:4608
    buffer_load_dwordx4 v3, s[4:7], s1 offen offset:2048 lds
    buffer_load_dwordx4 v4, s[4:7], s1 offen offset:3072 lds
    s_waitcnt lgkmcnt(10)
    v_mfma_f32_32x32x16_bf16 v[64:79], v[28:31], a[32:35], v[64:79]
    ds_read_b64_tr_b16 v[48:49], v18 offset:4096
    ds_read_b64_tr_b16 v[50:51], v18 offset:4608
    s_add_u32 m0, s60, 0
    s_mul_i32 s1, s63, 196608
    buffer_load_dwordx4 v5, s[8:11], s1 offen offset:0 lds
    buffer_load_dwordx4 v6, s[8:11], s1 offen offset:1024 lds
    s_add_u32 s63, s63, 1
    s_and_b32 s63, s63, 7
    s_waitcnt lgkmcnt(10)
    v_mfma_f32_32x32x16_bf16 v[80:95], v[32:35], a[32:35], v[80:95]
    ds_read_b128 a[44:47], v14 offset:32768
    ds_read_b64_tr_b16 v[52:53], v17 offset:6144
    ds_read_b64_tr_b16 v[54:55], v17 offset:6656
    s_add_u32 m0, s62, 20480
    s_mul_i32 s1, s0, 176128
    buffer_load_dwordx4 v7, s[16:19], s1 offen offset:0 lds
    buffer_load_dwordx4 v8, s[16:19], s1 offen offset:1024 lds
    s_waitcnt lgkmcnt(10)
    v_mfma_f32_32x32x16_bf16 v[64:79], v[36:39], a[36:39], v[64:79]
    ds_read_b64_tr_b16 v[56:57], v18 offset:6144
    ds_read_b64_tr_b16 v[58:59], v18 offset:6656
    buffer_load_dwordx4 v9, s[16:19], s1 offen offset:2048 lds
    s_add_u32 s0, s0, 1
    s_and_b32 s0, s0, 7
    s_waitcnt lgkmcnt(10)
    v_mfma_f32_32x32x16_bf16 v[80:95], v[40:43], a[36:39], v[80:95]
    s_waitcnt vmcnt(9)
    s_barrier
    ds_read_b128 a[48:51], v11 offset:0
    ds_read_b64_tr_b16 v[28:29], v17 offset:20480
    ds_read_b64_tr_b16 v[30:31], v17 offset:20992
    s_waitcnt lgkmcnt(10)
    v_mfma_f32_32x32x16_bf16 v[64:79], v[44:47], a[40:43], v[64:79]
    ds_read_b64_tr_b16 v[32:33], v18 offset:20480
    ds_read_b64_tr_b16 v[34:35], v18 offset:20992
    s_waitcnt lgkmcnt(10)
    v_mfma_f32_32x32x16_bf16 v[80:95], v[48:51], a[40:43], v[80:95]
    ds_read_b64_tr_b16 v[36:37], v19 offset:0
    ds_read_b64_tr_b16 v[38:39], v19 offset:768
    s_waitcnt lgkmcnt(9)
    v_mfma_f32_32x32x16_bf16 v[64:79], v[52:55], a[44:47], v[64:79]
    ds_read_b64_tr_b16 v[40:41], v19 offset:64
    ds_read_b64_tr_b16 v[42:43], v19 offset:832
    s_add_u32 m0, s59, 32768
    s_lshl_b32 s1, s63, 7
    buffer_load_dwordx4 v1, s[4:7], s1 offen offset:0 lds
    s_waitcnt lgkmcnt(9)
    v_mfma_f32_32x32x16_bf16 v[80:95], v[56:59], a[44:47], v[80:95]
    ds_read_b64_tr_b16 v[44:45], v19 offset:128
    ds_read_b64_tr_b16 v[46:47], v19 offset:896
    buffer_load_dwordx4 v2, s[4:7], s1 offen offset:1024 lds
    s_waitcnt lgkmcnt(8)
    v_mfma_f32_32x32x16_bf16 v[64:79], v[28:31], a[48:51], v[64:79]
    ds_read_b128 a[52:55], v12 offset:0
    ds_read_b64_tr_b16 v[48:49], v17 offset:22528
    ds_read_b64_tr_b16 v[50:51], v17 offset:23040
    s_waitcnt lgkmcnt(9)
    v_mfma_f32_32x32x16_bf16 v[80:95], v[32:35], a[48:51], v[80:95]
    ds_read_b64_tr_b16 v[52:53], v18 offset:22528
    ds_read_b64_tr_b16 v[54:55], v18 offset:23040
    buffer_load_dwordx4 v3, s[4:7], s1 offen offset:2048 lds
    s_waitcnt lgkmcnt(9)
    v_mfma_f32_32x32x16_bf16 v[112:127], v[36:39], a[0:3], v[112:127]
    ds_read_b64_tr_b16 v[56:57], v19 offset:3072
    ds_read_b64_tr_b16 v[58:59], v19 offset:3840
    s_waitcnt lgkmcnt(9)
    v_mfma_f32_32x32x16_bf16 v[128:143], v[40:43], a[0:3], v[128:143]
    ds_read_b64_tr_b16 v[28:29], v19 offset:3136
    ds_read_b64_tr_b16 v[30:31], v19 offset:3904
    buffer_load_dwordx4 v4, s[4:7], s1 offen offset:3072 lds
    s_waitcnt lgkmcnt(9)
    v_mfma_f32_32x32x16_bf16 v[144:159], v[44:47], a[0:3], v[144:159]
    ds_read_b64_tr_b16 v[32:33], v19 offset:3200
    ds_read_b64_tr_b16 v[34:35], v19 offset:3968
    s_waitcnt lgkmcnt(8)
    v_mfma_f32_32x32x16_bf16 v[64:79], v[48:51], a[52:55], v[64:79]
    ds_read_b128 a[56:59], v13 offset:0
    ds_read_b64_tr_b16 v[36:37], v17 offset:24576
    ds_read_b64_tr_b16 v[38:39], v17 offset:25088
    s_add_u32 m0, s60, 20480
    s_mul_i32 s1, s63, 196608
    buffer_load_dwordx4 v5, s[8:11], s1 offen offset:0 lds
    s_waitcnt lgkmcnt(9)
    v_mfma_f32_32x32x16_bf16 v[80:95], v[52:55], a[52:55], v[80:95]
    ds_read_b64_tr_b16 v[40:41], v18 offset:24576
    ds_read_b64_tr_b16 v[42:43], v18 offset:25088
    s_waitcnt lgkmcnt(9)
    v_mfma_f32_32x32x16_bf16 v[112:127], v[56:59], a[4:7], v[112:127]
    ds_read_b64_tr_b16 v[44:45], v19 offset:6144
    ds_read_b64_tr_b16 v[46:47], v19 offset:6912
    buffer_load_dwordx4 v6, s[8:11], s1 offen offset:1024 lds
    s_add_u32 s63, s63, 1
    s_and_b32 s63, s63, 7
    s_waitcnt lgkmcnt(9)
    v_mfma_f32_32x32x16_bf16 v[128:143], v[28:31], a[4:7], v[128:143]
    ds_read_b64_tr_b16 v[48:49], v19 offset:6208
    ds_read_b64_tr_b16 v[50:51], v19 offset:6976
    s_waitcnt lgkmcnt(9)
    v_mfma_f32_32x32x16_bf16 v[144:159], v[32:35], a[4:7], v[144:159]
    ds_read_b64_tr_b16 v[52:53], v19 offset:6272
    ds_read_b64_tr_b16 v[54:55], v19 offset:7040
    s_add_u32 m0, s62, 40960
    s_mul_i32 s1, s0, 176128
    buffer_load_dwordx4 v7, s[16:19], s1 offen offset:0 lds
    s_waitcnt lgkmcnt(8)
    v_mfma_f32_32x32x16_bf16 v[64:79], v[36:39], a[56:59], v[64:79]
    ds_read_b128 a[60:63], v14 offset:0
    ds_read_b64_tr_b16 v[56:57], v17 offset:26624
    ds_read_b64_tr_b16 v[58:59], v17 offset:27136
    s_waitcnt lgkmcnt(9)
    v_mfma_f32_32x32x16_bf16 v[80:95], v[40:43], a[56:59], v[80:95]
    ds_read_b64_tr_b16 v[28:29], v18 offset:26624
    ds_read_b64_tr_b16 v[30:31], v18 offset:27136
    buffer_load_dwordx4 v8, s[16:19], s1 offen offset:1024 lds
    s_waitcnt lgkmcnt(9)
    v_mfma_f32_32x32x16_bf16 v[112:127], v[44:47], a[8:11], v[112:127]
    ds_read_b64_tr_b16 v[32:33], v19 offset:9216
    ds_read_b64_tr_b16 v[34:35], v19 offset:9984
    s_waitcnt lgkmcnt(9)
    v_mfma_f32_32x32x16_bf16 v[128:143], v[48:51], a[8:11], v[128:143]
    ds_read_b64_tr_b16 v[36:37], v19 offset:9280
    ds_read_b64_tr_b16 v[38:39], v19 offset:10048
    buffer_load_dwordx4 v9, s[16:19], s1 offen offset:2048 lds
    s_add_u32 s0, s0, 1
    s_and_b32 s0, s0, 7
    s_waitcnt lgkmcnt(9)
    v_mfma_f32_32x32x16_bf16 v[144:159], v[52:55], a[8:11], v[144:159]
    ds_read_b64_tr_b16 v[40:41], v19 offset:9344
    ds_read_b64_tr_b16 v[42:43], v19 offset:10112
    s_waitcnt lgkmcnt(8)
    v_mfma_f32_32x32x16_bf16 v[64:79], v[56:59], a[60:63], v[64:79]
    s_waitcnt vmcnt(9)
    s_barrier
    ds_read_b128 a[64:67], v11 offset:16384
    ds_read_b64_tr_b16 v[44:45], v15 offset:0
    ds_read_b64_tr_b16 v[46:47], v15 offset:512
    buffer_load_dwordx4 v[100:103], v60, s[4:7], s70 offen offset:0
    buffer_load_dwordx4 v[104:107], v60, s[4:7], s70 offen offset:1024
    s_waitcnt lgkmcnt(9)
    v_mfma_f32_32x32x16_bf16 v[80:95], v[28:31], a[60:63], v[80:95]
    ds_read_b64_tr_b16 v[48:49], v16 offset:0
    ds_read_b64_tr_b16 v[50:51], v16 offset:512
    s_add_u32 m0, s59, 0
    s_lshl_b32 s1, s63, 7
    buffer_load_dwordx4 v1, s[4:7], s1 offen offset:0 lds
    s_waitcnt lgkmcnt(9)
    v_mfma_f32_32x32x16_bf16 v[112:127], v[32:35], a[12:15], v[112:127]
    ds_read_b64_tr_b16 v[52:53], v19 offset:20480
    ds_read_b64_tr_b16 v[54:55], v19 offset:21248
    s_waitcnt lgkmcnt(9)
    v_mfma_f32_32x32x16_bf16 v[128:143], v[36:39], a[12:15], v[128:143]
    ds_read_b64_tr_b16 v[56:57], v19 offset:20544
    ds_read_b64_tr_b16 v[58:59], v19 offset:21312
    buffer_load_dwordx4 v2, s[4:7], s1 offen offset:1024 lds
    s_waitcnt lgkmcnt(9)
    v_mfma_f32_32x32x16_bf16 v[144:159], v[40:43], a[12:15], v[144:159]
    ds_read_b64_tr_b16 v[28:29], v19 offset:20608
    ds_read_b64_tr_b16 v[30:31], v19 offset:21376
    s_waitcnt lgkmcnt(8)
    v_mfma_f32_32x32x16_bf16 v[64:79], v[44:47], a[64:67], v[64:79]
    ds_read_b128 a[68:71], v12 offset:16384
    ds_read_b64_tr_b16 v[32:33], v15 offset:2048
    ds_read_b64_tr_b16 v[34:35], v15 offset:2560
    buffer_load_dwordx4 v3, s[4:7], s1 offen offset:2048 lds
    s_waitcnt lgkmcnt(9)
    v_mfma_f32_32x32x16_bf16 v[80:95], v[48:51], a[64:67], v[80:95]
    ds_read_b64_tr_b16 v[36:37], v16 offset:2048
    ds_read_b64_tr_b16 v[38:39], v16 offset:2560
    s_waitcnt lgkmcnt(9)
    v_mfma_f32_32x32x16_bf16 v[112:127], v[52:55], a[16:19], v[112:127]
    ds_read_b64_tr_b16 v[40:41], v19 offset:23552
    ds_read_b64_tr_b16 v[42:43], v19 offset:24320
    buffer_load_dwordx4 v4, s[4:7], s1 offen offset:3072 lds
    s_waitcnt lgkmcnt(9)
    v_mfma_f32_32x32x16_bf16 v[128:143], v[56:59], a[16:19], v[128:143]
    ds_read_b64_tr_b16 v[44:45], v19 offset:23616
    ds_read_b64_tr_b16 v[46:47], v19 offset:24384
    s_waitcnt lgkmcnt(9)
    v_mfma_f32_32x32x16_bf16 v[144:159], v[28:31], a[16:19], v[144:159]
    ds_read_b64_tr_b16 v[48:49], v19 offset:23680
    ds_read_b64_tr_b16 v[50:51], v19 offset:24448
    s_add_u32 m0, s60, 40960
    s_mul_i32 s1, s63, 196608
    buffer_load_dwordx4 v5, s[8:11], s1 offen offset:0 lds
    s_waitcnt lgkmcnt(8)
    v_mfma_f32_32x32x16_bf16 v[64:79], v[32:35], a[68:71], v[64:79]
    ds_read_b128 a[72:75], v13 offset:16384
    ds_read_b64_tr_b16 v[52:53], v15 offset:4096
    ds_read_b64_tr_b16 v[54:55], v15 offset:4608
    s_waitcnt lgkmcnt(9)
    v_mfma_f32_32x32x16_bf16 v[80:95], v[36:39], a[68:71], v[80:95]
    ds_read_b64_tr_b16 v[56:57], v16 offset:4096
    ds_read_b64_tr_b16 v[58:59], v16 offset:4608
    buffer_load_dwordx4 v6, s[8:11], s1 offen offset:1024 lds
    s_add_u32 s63, s63, 1
    s_and_b32 s63, s63, 7
    s_waitcnt lgkmcnt(9)
    v_mfma_f32_32x32x16_bf16 v[112:127], v[40:43], a[20:23], v[112:127]
    ds_read_b64_tr_b16 v[28:29], v19 offset:26624
    ds_read_b64_tr_b16 v[30:31], v19 offset:27392
    s_waitcnt lgkmcnt(9)
    v_mfma_f32_32x32x16_bf16 v[128:143], v[44:47], a[20:23], v[128:143]
    ds_read_b64_tr_b16 v[32:33], v19 offset:26688
    ds_read_b64_tr_b16 v[34:35], v19 offset:27456
    s_add_u32 m0, s62, 61440
    s_mul_i32 s1, s0, 176128
    buffer_load_dwordx4 v7, s[16:19], s1 offen offset:0 lds
    s_waitcnt lgkmcnt(9)
    v_mfma_f32_32x32x16_bf16 v[144:159], v[48:51], a[20:23], v[144:159]
    ds_read_b64_tr_b16 v[36:37], v19 offset:26752
    ds_read_b64_tr_b16 v[38:39], v19 offset:27520
    s_waitcnt lgkmcnt(8)
    v_mfma_f32_32x32x16_bf16 v[64:79], v[52:55], a[72:75], v[64:79]
    ds_read_b128 a[76:79], v14 offset:16384
    ds_read_b64_tr_b16 v[40:41], v15 offset:6144
    ds_read_b64_tr_b16 v[42:43], v15 offset:6656
    buffer_load_dwordx4 v8, s[16:19], s1 offen offset:1024 lds
    s_waitcnt lgkmcnt(9)
    v_mfma_f32_32x32x16_bf16 v[80:95], v[56:59], a[72:75], v[80:95]
    ds_read_b64_tr_b16 v[44:45], v16 offset:6144
    ds_read_b64_tr_b16 v[46:47], v16 offset:6656
    s_waitcnt lgkmcnt(9)
    v_mfma_f32_32x32x16_bf16 v[112:127], v[28:31], a[24:27], v[112:127]
    ds_read_b64_tr_b16 v[48:49], v19 offset:29696
    ds_read_b64_tr_b16 v[50:51], v19 offset:30464
    buffer_load_dwordx4 v9, s[16:19], s1 offen offset:2048 lds
    s_add_u32 s0, s0, 1
    s_and_b32 s0, s0, 7
    s_waitcnt lgkmcnt(9)
    v_mfma_f32_32x32x16_bf16 v[128:143], v[32:35], a[24:27], v[128:143]
    ds_read_b64_tr_b16 v[52:53], v19 offset:29760
    ds_read_b64_tr_b16 v[54:55], v19 offset:30528
    s_waitcnt lgkmcnt(9)
    v_mfma_f32_32x32x16_bf16 v[144:159], v[36:39], a[24:27], v[144:159]
    ds_read_b64_tr_b16 v[56:57], v19 offset:29824
    ds_read_b64_tr_b16 v[58:59], v19 offset:30592
    s_waitcnt lgkmcnt(8)
    v_mfma_f32_32x32x16_bf16 v[64:79], v[40:43], a[76:79], v[64:79]
    s_waitcnt vmcnt(11)
    s_barrier
    ds_read_b128 a[80:83], v11 offset:32768
    ds_read_b64_tr_b16 v[28:29], v15 offset:20480
    ds_read_b64_tr_b16 v[30:31], v15 offset:20992
    s_waitcnt lgkmcnt(9)
    v_mfma_f32_32x32x16_bf16 v[80:95], v[44:47], a[76:79], v[80:95]
    ds_read_b64_tr_b16 v[32:33], v16 offset:20480
    ds_read_b64_tr_b16 v[34:35], v16 offset:20992
    s_add_u32 m0, s59, 16384
    s_lshl_b32 s1, s63, 7
    buffer_load_dwordx4 v1, s[4:7], s1 offen offset:0 lds
    s_waitcnt lgkmcnt(9)
    v_mfma_f32_32x32x16_bf16 v[112:127], v[48:51], a[28:31], v[112:127]
    ds_read_b64_tr_b16 v[36:37], v20 offset:0
    ds_read_b64_tr_b16 v[38:39], v20 offset:768
    s_waitcnt lgkmcnt(9)
    v_mfma_f32_32x32x16_bf16 v[128:143], v[52:55], a[28:31], v[128:143]
    ds_read_b64_tr_b16 v[40:41], v20 offset:64
    ds_read_b64_tr_b16 v[42:43], v20 offset:832
    buffer_load_dwordx4 v2, s[4:7], s1 offen offset:1024 lds
    s_waitcnt lgkmcnt(9)
    v_mfma_f32_32x32x16_bf16 v[144:159], v[56:59], a[28:31], v[144:159]
    ds_read_b64_tr_b16 v[44:45], v20 offset:128
    ds_read_b64_tr_b16 v[46:47], v20 offset:896
    s_waitcnt lgkmcnt(8)
    v_mfma_f32_32x32x16_bf16 v[64:79], v[28:31], a[80:83], v[64:79]
    ds_read_b128 a[84:87], v12 offset:32768
    ds_read_b64_tr_b16 v[48:49], v15 offset:22528
    ds_read_b64_tr_b16 v[50:51], v15 offset:23040
    buffer_load_dwordx4 v3, s[4:7], s1 offen offset:2048 lds
    s_waitcnt lgkmcnt(9)
    v_mfma_f32_32x32x16_bf16 v[80:95], v[32:35], a[80:83], v[80:95]
    ds_read_b64_tr_b16 v[52:53], v16 offset:22528
    ds_read_b64_tr_b16 v[54:55], v16 offset:23040
    s_waitcnt lgkmcnt(9)
    v_mfma_f32_32x32x16_bf16 v[112:127], v[36:39], a[32:35], v[112:127]
    ds_read_b64_tr_b16 v[56:57], v20 offset:3072
    ds_read_b64_tr_b16 v[58:59], v20 offset:3840
    buffer_load_dwordx4 v4, s[4:7], s1 offen offset:3072 lds
    s_waitcnt lgkmcnt(9)
    v_mfma_f32_32x32x16_bf16 v[128:143], v[40:43], a[32:35], v[128:143]
    ds_read_b64_tr_b16 v[28:29], v20 offset:3136
    ds_read_b64_tr_b16 v[30:31], v20 offset:3904
    s_waitcnt lgkmcnt(9)
    v_mfma_f32_32x32x16_bf16 v[144:159], v[44:47], a[32:35], v[144:159]
    ds_read_b64_tr_b16 v[32:33], v20 offset:3200
    ds_read_b64_tr_b16 v[34:35], v20 offset:3968
    s_add_u32 m0, s60, 61440
    s_mul_i32 s1, s63, 196608
    buffer_load_dwordx4 v5, s[8:11], s1 offen offset:0 lds
    s_waitcnt lgkmcnt(8)
    v_mfma_f32_32x32x16_bf16 v[64:79], v[48:51], a[84:87], v[64:79]
    ds_read_b128 a[88:91], v13 offset:32768
    ds_read_b64_tr_b16 v[36:37], v15 offset:24576
    ds_read_b64_tr_b16 v[38:39], v15 offset:25088
    s_waitcnt lgkmcnt(9)
    v_mfma_f32_32x32x16_bf16 v[80:95], v[52:55], a[84:87], v[80:95]
    ds_read_b64_tr_b16 v[40:41], v16 offset:24576
    ds_read_b64_tr_b16 v[42:43], v16 offset:25088
    buffer_load_dwordx4 v6, s[8:11], s1 offen offset:1024 lds
    s_add_u32 s63, s63, 1
    s_and_b32 s63, s63, 7
    s_waitcnt lgkmcnt(9)
    v_mfma_f32_32x32x16_bf16 v[112:127], v[56:59], a[36:39], v[112:127]
    ds_read_b64_tr_b16 v[44:45], v20 offset:6144
    ds_read_b64_tr_b16 v[46:47], v20 offset:6912
    s_waitcnt lgkmcnt(9)
    v_mfma_f32_32x32x16_bf16 v[128:143], v[28:31], a[36:39], v[128:143]
    ds_read_b64_tr_b16 v[48:49], v20 offset:6208
    ds_read_b64_tr_b16 v[50:51], v20 offset:6976
    s_add_u32 m0, s62, 0
    s_mul_i32 s1, s0, 176128
    buffer_load_dwordx4 v7, s[16:19], s1 offen offset:0 lds
    s_waitcnt lgkmcnt(9)
    v_mfma_f32_32x32x16_bf16 v[144:159], v[32:35], a[36:39], v[144:159]
    ds_read_b64_tr_b16 v[52:53], v20 offset:6272
    ds_read_b64_tr_b16 v[54:55], v20 offset:7040
    s_waitcnt lgkmcnt(8)
    v_mfma_f32_32x32x16_bf16 v[64:79], v[36:39], a[88:91], v[64:79]
    ds_read_b128 a[92:95], v14 offset:32768
    ds_read_b64_tr_b16 v[56:57], v15 offset:26624
    ds_read_b64_tr_b16 v[58:59], v15 offset:27136
    buffer_load_dwordx4 v8, s[16:19], s1 offen offset:1024 lds
    s_waitcnt lgkmcnt(9)
    v_mfma_f32_32x32x16_bf16 v[80:95], v[40:43], a[88:91], v[80:95]
    ds_read_b64_tr_b16 v[28:29], v16 offset:26624
    ds_read_b64_tr_b16 v[30:31], v16 offset:27136
    s_waitcnt lgkmcnt(9)
    v_mfma_f32_32x32x16_bf16 v[112:127], v[44:47], a[40:43], v[112:127]
    ds_read_b64_tr_b16 v[32:33], v20 offset:9216
    ds_read_b64_tr_b16 v[34:35], v20 offset:9984
    buffer_load_dwordx4 v9, s[16:19], s1 offen offset:2048 lds
    s_add_u32 s0, s0, 1
    s_and_b32 s0, s0, 7
    s_waitcnt lgkmcnt(9)
    v_mfma_f32_32x32x16_bf16 v[128:143], v[48:51], a[40:43], v[128:143]
    ds_read_b64_tr_b16 v[36:37], v20 offset:9280
    ds_read_b64_tr_b16 v[38:39], v20 offset:10048
    s_waitcnt lgkmcnt(9)
    v_mfma_f32_32x32x16_bf16 v[144:159], v[52:55], a[40:43], v[144:159]
    ds_read_b64_tr_b16 v[40:41], v20 offset:9344
    ds_read_b64_tr_b16 v[42:43], v20 offset:10112
    s_waitcnt lgkmcnt(8)
    v_mfma_f32_32x32x16_bf16 v[64:79], v[56:59], a[92:95], v[64:79]
    s_waitcnt vmcnt(9)
    s_barrier
    ds_read_b128 a[96:99], v11 offset:0
    ds_read_b64_tr_b16 v[44:45], v17 offset:0
    ds_read_b64_tr_b16 v[46:47], v17 offset:512
    s_waitcnt lgkmcnt(9)
    v_mfma_f32_32x32x16_bf16 v[80:95], v[28:31], a[92:95], v[80:95]
    ds_read_b64_tr_b16 v[48:49], v18 offset:0
    ds_read_b64_tr_b16 v[50:51], v18 offset:512
    s_add_u32 m0, s62, 20480
    s_mul_i32 s1, s0, 176128
    buffer_load_dwordx4 v7, s[16:19], s1 offen offset:0 lds
    s_waitcnt lgkmcnt(9)
    v_mfma_f32_32x32x16_bf16 v[112:127], v[32:35], a[44:47], v[112:127]
    ds_read_b64_tr_b16 v[52:53], v20 offset:20480
    ds_read_b64_tr_b16 v[54:55], v20 offset:21248
    v_mov_b32 v24, 0
    v_mov_b32 v25, 0
    s_waitcnt lgkmcnt(9)
    v_mfma_f32_32x32x16_bf16 v[128:143], v[36:39], a[44:47], v[128:143]
    ds_read_b64_tr_b16 v[56:57], v20 offset:20544
    ds_read_b64_tr_b16 v[58:59], v20 offset:21312
    v_dot2c_f32_bf16 v24, v100, v96
    v_dot2c_f32_bf16 v25, v104, v96
    s_waitcnt lgkmcnt(9)
    v_mfma_f32_32x32x16_bf16 v[144:159], v[40:43], a[44:47], v[144:159]
    ds_read_b64_tr_b16 v[28:29], v20 offset:20608
    ds_read_b64_tr_b16 v[30:31], v20 offset:21376
    buffer_load_dwordx4 v8, s[16:19], s1 offen offset:1024 lds
    v_dot2c_f32_bf16 v24, v101, v97
    v_dot2c_f32_bf16 v25, v105, v97
    s_waitcnt lgkmcnt(8)
    v_mfma_f32_32x32x16_bf16 v[64:79], v[44:47], a[96:99], v[64:79]
    ds_read_b128 a[100:103], v12 offset:0
    ds_read_b64_tr_b16 v[32:33], v17 offset:2048
    ds_read_b64_tr_b16 v[34:35], v17 offset:2560
    v_dot2c_f32_bf16 v24, v102, v98
    v_dot2c_f32_bf16 v25, v106, v98
    s_waitcnt lgkmcnt(9)
    v_mfma_f32_32x32x16_bf16 v[80:95], v[48:51], a[96:99], v[80:95]
    ds_read_b64_tr_b16 v[36:37], v18 offset:2048
    ds_read_b64_tr_b16 v[38:39], v18 offset:2560
    v_dot2c_f32_bf16 v24, v103, v99
    v_dot2c_f32_bf16 v25, v107, v99
    s_waitcnt lgkmcnt(9)
    v_mfma_f32_32x32x16_bf16 v[112:127], v[52:55], a[48:51], v[112:127]
    ds_read_b64_tr_b16 v[40:41], v20 offset:23552
    ds_read_b64_tr_b16 v[42:43], v20 offset:24320
    buffer_load_dwordx4 v9, s[16:19], s1 offen offset:2048 lds
    s_add_u32 s0, s0, 1
    s_and_b32 s0, s0, 7
    v_add_f32_dpp v24, v24, v24 row_shr:1
    v_add_f32_dpp v25, v25, v25 row_shr:1
    s_waitcnt lgkmcnt(9)
    v_mfma_f32_32x32x16_bf16 v[128:143], v[56:59], a[48:51], v[128:143]
    ds_read_b64_tr_b16 v[44:45], v20 offset:23616
    ds_read_b64_tr_b16 v[46:47], v20 offset:24384
    v_add_f32_dpp v24, v24, v24 row_shr:2
    v_add_f32_dpp v25, v25, v25 row_shr:2
    s_waitcnt lgkmcnt(9)
    v_mfma_f32_32x32x16_bf16 v[144:159], v[28:31], a[48:51], v[144:159]
    ds_read_b64_tr_b16 v[48:49], v20 offset:23680
    ds_read_b64_tr_b16 v[50:51], v20 offset:24448
    v_add_f32_dpp v24, v24, v24 row_shr:4
    v_add_f32_dpp v25, v25, v25 row_shr:4
    s_waitcnt lgkmcnt(8)
    v_mfma_f32_32x32x16_bf16 v[64:79], v[32:35], a[100:103], v[64:79]
    ds_read_b128 a[104:107], v13 offset:0
    ds_read_b64_tr_b16 v[52:53], v17 offset:4096
    ds_read_b64_tr_b16 v[54:55], v17 offset:4608
    s_add_u32 m0, s61, 4096
    s_mul_i32 s1, s64, 196608
    buffer_load_dwordx4 v10, s[8:11], s1 offen lds
    s_add_u32 s64, s64, 1
    s_and_b32 s64, s64, 7
    v_add_f32_dpp v24, v24, v24 row_shr:8
    v_add_f32_dpp v25, v25, v25 row_shr:8
    s_waitcnt lgkmcnt(9)
    v_mfma_f32_32x32x16_bf16 v[80:95], v[36:39], a[100:103], v[80:95]
    ds_read_b64_tr_b16 v[56:57], v18 offset:4096
    ds_read_b64_tr_b16 v[58:59], v18 offset:4608
    v_add_f32_dpp v24, v24, v24 row_bcast:15 row_mask:0xa
    v_add_f32_dpp v25, v25, v25 row_bcast:15 row_mask:0xa
    s_waitcnt lgkmcnt(9)
    v_mfma_f32_32x32x16_bf16 v[112:127], v[40:43], a[52:55], v[112:127]
    ds_read_b64_tr_b16 v[28:29], v20 offset:26624
    ds_read_b64_tr_b16 v[30:31], v20 offset:27392
    v_add_f32_dpp v24, v24, v24 row_bcast:31 row_mask:0xc
    v_add_f32_dpp v25, v25, v25 row_bcast:31 row_mask:0xc
    s_waitcnt lgkmcnt(9)
    v_mfma_f32_32x32x16_bf16 v[128:143], v[44:47], a[52:55], v[128:143]
    ds_read_b64_tr_b16 v[32:33], v20 offset:26688
    ds_read_b64_tr_b16 v[34:35], v20 offset:27456
    s_add_u32 m0, s61, 8192
    s_mul_i32 s1, s64, 196608
    buffer_load_dwordx4 v10, s[8:11], s1 offen lds
    s_add_u32 s64, s64, 1
    s_and_b32 s64, s64, 7
    v_mul_f32 v24, 0xbfb8aa3b, v24
    v_mul_f32 v25, 0xbfb8aa3b, v25
    s_waitcnt lgkmcnt(9)
    v_mfma_f32_32x32x16_bf16 v[144:159], v[48:51], a[52:55], v[144:159]
    ds_read_b64_tr_b16 v[36:37], v20 offset:26752
    ds_read_b64_tr_b16 v[38:39], v20 offset:27520
    v_exp_f32_e64 v24, v24
    v_exp_f32 v25, v25
    s_waitcnt lgkmcnt(8)
    v_mfma_f32_32x32x16_bf16 v[64:79], v[52:55], a[104:107], v[64:79]
    ds_read_b128 a[108:111], v14 offset:0
    ds_read_b64_tr_b16 v[40:41], v17 offset:6144
    ds_read_b64_tr_b16 v[42:43], v17 offset:6656
    v_add_f32_e64 v24, 1.0, v24
    v_add_f32 v25, 1.0, v25
    s_waitcnt lgkmcnt(9)
    v_mfma_f32_32x32x16_bf16 v[80:95], v[56:59], a[104:107], v[80:95]
    ds_read_b64_tr_b16 v[44:45], v18 offset:6144
    ds_read_b64_tr_b16 v[46:47], v18 offset:6656
    s_add_u32 m0, s61, 12288
    s_mul_i32 s1, s64, 196608
    buffer_load_dwordx4 v10, s[8:11], s1 offen lds
    s_add_u32 s64, s64, 1
    s_and_b32 s64, s64, 7
    v_rcp_f32 v24, v24
    v_rcp_f32 v25, v25
    s_waitcnt lgkmcnt(9)
    v_mfma_f32_32x32x16_bf16 v[112:127], v[28:31], a[56:59], v[112:127]
    ds_read_b64_tr_b16 v[48:49], v20 offset:29696
    ds_read_b64_tr_b16 v[50:51], v20 offset:30464
    s_waitcnt lgkmcnt(9)
    v_mfma_f32_32x32x16_bf16 v[128:143], v[32:35], a[56:59], v[128:143]
    ds_read_b64_tr_b16 v[52:53], v20 offset:29760
    ds_read_b64_tr_b16 v[54:55], v20 offset:30528
    s_waitcnt lgkmcnt(9)
    v_mfma_f32_32x32x16_bf16 v[144:159], v[36:39], a[56:59], v[144:159]
    ds_read_b64_tr_b16 v[56:57], v20 offset:29824
    ds_read_b64_tr_b16 v[58:59], v20 offset:30592
    s_waitcnt lgkmcnt(8)
    v_mfma_f32_32x32x16_bf16 v[64:79], v[40:43], a[108:111], v[64:79]
    s_waitcnt vmcnt(6)
    s_barrier
    ds_read_b128 a[112:115], v11 offset:16384
    ds_read_b64_tr_b16 v[28:29], v17 offset:20480
    ds_read_b64_tr_b16 v[30:31], v17 offset:20992
    s_waitcnt lgkmcnt(9)
    v_mfma_f32_32x32x16_bf16 v[80:95], v[44:47], a[108:111], v[80:95]
    ds_read_b64_tr_b16 v[32:33], v18 offset:20480
    ds_read_b64_tr_b16 v[34:35], v18 offset:20992
    s_add_u32 m0, s62, 40960
    s_mul_i32 s1, s0, 176128
    buffer_load_dwordx4 v7, s[16:19], s1 offen offset:0 lds
    s_waitcnt lgkmcnt(9)
    v_mfma_f32_32x32x16_bf16 v[112:127], v[48:51], a[60:63], v[112:127]
    ds_read_b128 a[116:119], v12 offset:16384
    ds_read_b64_tr_b16 v[36:37], v17 offset:22528
    ds_read_b64_tr_b16 v[38:39], v17 offset:23040
    s_waitcnt lgkmcnt(10)
    v_mfma_f32_32x32x16_bf16 v[128:143], v[52:55], a[60:63], v[128:143]
    ds_read_b64_tr_b16 v[40:41], v18 offset:22528
    ds_read_b64_tr_b16 v[42:43], v18 offset:23040
    s_waitcnt lgkmcnt(10)
    v_mfma_f32_32x32x16_bf16 v[144:159], v[56:59], a[60:63], v[144:159]
    ds_read_b128 a[120:123], v13 offset:16384
    ds_read_b64_tr_b16 v[44:45], v17 offset:24576
    ds_read_b64_tr_b16 v[46:47], v17 offset:25088
    s_add_u32 m0, s62, 40960
    s_nop 0
    buffer_load_dwordx4 v8, s[16:19], s1 offen offset:1024 lds
    s_waitcnt lgkmcnt(10)
    v_mfma_f32_32x32x16_bf16 v[64:79], v[28:31], a[112:115], v[64:79]
    ds_read_b64_tr_b16 v[48:49], v18 offset:24576
    ds_read_b64_tr_b16 v[50:51], v18 offset:25088
    s_waitcnt lgkmcnt(10)
    v_mfma_f32_32x32x16_bf16 v[80:95], v[32:35], a[112:115], v[80:95]
    ds_read_b128 a[124:127], v14 offset:16384
    ds_read_b64_tr_b16 v[52:53], v17 offset:26624
    ds_read_b64_tr_b16 v[54:55], v17 offset:27136
    s_waitcnt lgkmcnt(10)
    v_mfma_f32_32x32x16_bf16 v[64:79], v[36:39], a[116:119], v[64:79]
    ds_read_b64_tr_b16 v[56:57], v18 offset:26624
    ds_read_b64_tr_b16 v[58:59], v18 offset:27136
    s_add_u32 m0, s62, 40960
    s_nop 0
    buffer_load_dwordx4 v9, s[16:19], s1 offen offset:2048 lds
    s_add_u32 s0, s0, 1
    s_and_b32 s0, s0, 7
    s_waitcnt lgkmcnt(10)
    v_mfma_f32_32x32x16_bf16 v[80:95], v[40:43], a[116:119], v[80:95]
    ds_read_b64_tr_b16 v[28:29], v19 offset:0
    ds_read_b64_tr_b16 v[30:31], v19 offset:768
    s_waitcnt lgkmcnt(9)
    v_mfma_f32_32x32x16_bf16 v[64:79], v[44:47], a[120:123], v[64:79]
    ds_read_b64_tr_b16 v[32:33], v19 offset:64
    ds_read_b64_tr_b16 v[34:35], v19 offset:832
    s_waitcnt lgkmcnt(9)
    v_mfma_f32_32x32x16_bf16 v[80:95], v[48:51], a[120:123], v[80:95]
    ds_read_b64_tr_b16 v[36:37], v19 offset:128
    ds_read_b64_tr_b16 v[38:39], v19 offset:896
    s_add_u32 m0, s61, 16384
    s_mul_i32 s1, s64, 196608
    buffer_load_dwordx4 v10, s[8:11], s1 offen lds
    s_add_u32 s64, s64, 1
    s_and_b32 s64, s64, 7
    s_waitcnt lgkmcnt(8)
    v_mfma_f32_32x32x16_bf16 v[64:79], v[52:55], a[124:127], v[64:79]
    ds_read_b64_tr_b16 v[40:41], v19 offset:3072
    ds_read_b64_tr_b16 v[42:43], v19 offset:3840
    s_waitcnt lgkmcnt(8)
    v_mfma_f32_32x32x16_bf16 v[80:95], v[56:59], a[124:127], v[80:95]
    ds_read_b64_tr_b16 v[44:45], v19 offset:3136
    ds_read_b64_tr_b16 v[46:47], v19 offset:3904
    s_branch PA_DONE
PA_V:
    s_add_u32 m0, s59, 16384
    s_lshl_b32 s1, s63, 7
    buffer_load_dwordx4 v1, s[4:7], s1 offen offset:0 lds
    buffer_load_dwordx4 v2, s[4:7], s1 offen offset:1024 lds
    buffer_load_dwordx4 v3, s[4:7], s1 offen offset:2048 lds
    buffer_load_dwordx4 v4, s[4:7], s1 offen offset:3072 lds
    s_add_u32 m0, s60, 20480
    s_mul_i32 s1, s63, 196608
    buffer_load_dwordx4 v5, s[8:11], s1 offen offset:0 lds
    buffer_load_dwordx4 v6, s[8:11], s1 offen offset:1024 lds
    s_add_u32 s63, s63, 1
    s_and_b32 s63, s63, 7
    s_waitcnt vmcnt(6)
    s_cmp_eq_u32 s42, 0
    s_cbranch_scc1 GOV
NOGOV:
    s_barrier
    ds_read_b128 a[0:3], v11 offset:0
    ds_read_b64_tr_b16 v[28:29], v15 offset:0
    ds_read_b64_tr_b16 v[30:31], v15 offset:512
    ds_read_b64_tr_b16 v[32:33], v16 offset:0
    ds_read_b64_tr_b16 v[34:35], v16 offset:512
    ds_read_b128 a[4:7], v12 offset:0
    ds_read_b64_tr_b16 v[36:37], v15 offset:2048
    ds_read_b64_tr_b16 v[38:39], v15 offset:2560
    ds_read_b64_tr_b16 v[40:41], v16 offset:2048
    ds_read_b64_tr_b16 v[42:43], v16 offset:2560
    ds_read_b128 a[8:11], v13 offset:0
    ds_read_b64_tr_b16 v[44:45], v15 offset:4096
    ds_read_b64_tr_b16 v[46:47], v15 offset:4608
    v_mfma_f32_32x32x16_bf16 v[112:127], v[160:163], v[168:171], 0
    v_mfma_f32_32x32x16_bf16 v[128:143], v[160:163], v[172:175], 0
    v_mfma_f32_32x32x16_bf16 v[144:159], v[164:167], v[168:171], 0
    s_waitcnt lgkmcnt(10)
    v_mfma_f32_32x32x16_bf16 v[64:79], a[0:3], v[28:31], 0
    ds_read_b64_tr_b16 v[48:49], v16 offset:4096
    ds_read_b64_tr_b16 v[50:51], v16 offset:4608
    s_add_u32 m0, s59, 32768
    s_lshl_b32 s1, s63, 7
    buffer_load_dwordx4 v1, s[4:7], s1 offen offset:0 lds
    buffer_load_dwordx4 v2, s[4:7], s1 offen offset:1024 lds
    s_waitcnt lgkmcnt(10)
    v_mfma_f32_32x32x16_bf16 v[80:95], a[0:3], v[32:35], 0
    ds_read_b128 a[12:15], v14 offset:0
    ds_read_b64_tr_b16 v[52:53], v15 offset:6144
    ds_read_b64_tr_b16 v[54:55], v15 offset:6656
    buffer_load_dwordx4 v3, s[4:7], s1 offen offset:2048 lds
    buffer_load_dwordx4 v4, s[4:7], s1 offen offset:3072 lds
    s_waitcnt lgkmcnt(10)
    v_mfma_f32_32x32x16_bf16 v[64:79], a[4:7], v[36:39], v[64:79]
    ds_read_b64_tr_b16 v[56:57], v16 offset:6144
    ds_read_b64_tr_b16 v[58:59], v16 offset:6656
    s_add_u32 m0, s60, 40960
    s_mul_i32 s1, s63, 196608
    buffer_load_dwordx4 v5, s[8:11], s1 offen offset:0 lds
    buffer_load_dwordx4 v6, s[8:11], s1 offen offset:1024 lds
    s_add_u32 s63, s63, 1
    s_and_b32 s63, s63, 7
    s_waitcnt lgkmcnt(10)
    v_mfma_f32_32x32x16_bf16 v[80:95], a[4:7], v[40:43], v[80:95]
    s_waitcnt vmcnt(6)
    s_barrier
    ds_read_b128 a[16:19], v11 offset:16384
    ds_read_b64_tr_b16 v[28:29], v15 offset:20480
    ds_read_b64_tr_b16 v[30:31], v15 offset:20992
    s_waitcnt lgkmcnt(10)
    v_mfma_f32_32x32x16_bf16 v[64:79], a[8:11], v[44:47], v[64:79]
    ds_read_b64_tr_b16 v[32:33], v16 offset:20480
    ds_read_b64_tr_b16 v[34:35], v16 offset:20992
    s_waitcnt lgkmcnt(10)
    v_mfma_f32_32x32x16_bf16 v[80:95], a[8:11], v[48:51], v[80:95]
    ds_read_b128 a[20:23], v12 offset:16384
    ds_read_b64_tr_b16 v[36:37], v15 offset:22528
    ds_read_b64_tr_b16 v[38:39], v15 offset:23040
    s_waitcnt lgkmcnt(10)
    v_mfma_f32_32x32x16_bf16 v[64:79], a[12:15], v[52:55], v[64:79]
    ds_read_b64_tr_b16 v[40:41], v16 offset:22528
    ds_read_b64_tr_b16 v[42:43], v16 offset:23040
    s_add_u32 m0, s59, 0
    s_lshl_b32 s1, s63, 7
    buffer_load_dwordx4 v1, s[4:7], s1 offen offset:0 lds
    buffer_load_dwordx4 v2, s[4:7], s1 offen offset:1024 lds
    s_waitcnt lgkmcnt(10)
    v_mfma_f32_32x32x16_bf16 v[80:95], a[12:15], v[56:59], v[80:95]
    ds_read_b128 a[24:27], v13 offset:16384
    ds_read_b64_tr_b16 v[44:45], v15 offset:24576
    ds_read_b64_tr_b16 v[46:47], v15 offset:25088
    buffer_load_dwordx4 v3, s[4:7], s1 offen offset:2048 lds
    s_waitcnt lgkmcnt(10)
    v_mfma_f32_32x32x16_bf16 v[64:79], a[16:19], v[28:31], v[64:79]
    ds_read_b64_tr_b16 v[48:49], v16 offset:24576
    ds_read_b64_tr_b16 v[50:51], v16 offset:25088
    buffer_load_dwordx4 v4, s[4:7], s1 offen offset:3072 lds
    s_waitcnt lgkmcnt(10)
    v_mfma_f32_32x32x16_bf16 v[80:95], a[16:19], v[32:35], v[80:95]
    ds_read_b128 a[28:31], v14 offset:16384
    ds_read_b64_tr_b16 v[52:53], v15 offset:26624
    ds_read_b64_tr_b16 v[54:55], v15 offset:27136
    s_add_u32 m0, s60, 61440
    s_mul_i32 s1, s63, 196608
    buffer_load_dwordx4 v5, s[8:11], s1 offen offset:0 lds
    s_waitcnt lgkmcnt(10)
    v_mfma_f32_32x32x16_bf16 v[64:79], a[20:23], v[36:39], v[64:79]
    ds_read_b64_tr_b16 v[56:57], v16 offset:26624
    ds_read_b64_tr_b16 v[58:59], v16 offset:27136
    buffer_load_dwordx4 v6, s[8:11], s1 offen offset:1024 lds
    s_add_u32 s63, s63, 1
    s_and_b32 s63, s63, 7
    s_waitcnt lgkmcnt(10)
    v_mfma_f32_32x32x16_bf16 v[80:95], a[20:23], v[40:43], v[80:95]
    s_waitcnt vmcnt(6)
    s_barrier
    ds_read_b128 a[32:35], v11 offset:32768
    ds_read_b64_tr_b16 v[28:29], v17 offset:0
    ds_read_b64_tr_b16 v[30:31], v17 offset:512
    s_waitcnt lgkmcnt(10)
    v_mfma_f32_32x32x16_bf16 v[64:79], a[24:27], v[44:47], v[64:79]
    ds_read_b64_tr_b16 v[32:33], v18 offset:0
    ds_read_b64_tr_b16 v[34:35], v18 offset:512
    s_waitcnt lgkmcnt(10)
    v_mfma_f32_32x32x16_bf16 v[80:95], a[24:27], v[48:51], v[80:95]
    ds_read_b128 a[36:39], v12 offset:32768
    ds_read_b64_tr_b16 v[36:37], v17 offset:2048
    ds_read_b64_tr_b16 v[38:39], v17 offset:2560
    s_waitcnt lgkmcnt(10)
    v_mfma_f32_32x32x16_bf16 v[64:79], a[28:31], v[52:55], v[64:79]
    ds_read_b64_tr_b16 v[40:41], v18 offset:2048
    ds_read_b64_tr_b16 v[42:43], v18 offset:2560
    s_add_u32 m0, s59, 16384
    s_lshl_b32 s1, s63, 7
    buffer_load_dwordx4 v1, s[4:7], s1 offen offset:0 lds
    buffer_load_dwordx4 v2, s[4:7], s1 offen offset:1024 lds
    s_waitcnt lgkmcnt(10)
    v_mfma_f32_32x32x16_bf16 v[80:95], a[28:31], v[56:59], v[80:95]
    ds_read_b128 a[40:43], v13 offset:32768
    ds_read_b64_tr_b16 v[44:45], v17 offset:4096
    ds_read_b64_tr_b16 v[46:47], v17 offset:4608
    buffer_load_dwordx4 v3, s[4:7], s1 offen offset:2048 lds
    buffer_load_dwordx4 v4, s[4:7], s1 offen offset:3072 lds
    s_waitcnt lgkmcnt(10)
    v_mfma_f32_32x32x16_bf16 v[64:79], a[32:35], v[28:31], v[64:79]
    ds_read_b64_tr_b16 v[48:49], v18 offset:4096
    ds_read_b64_tr_b16 v[50:51], v18 offset:4608
    s_add_u32 m0, s60, 0
    s_mul_i32 s1, s63, 196608
    buffer_load_dwordx4 v5, s[8:11], s1 offen offset:0 lds
    buffer_load_dwordx4 v6, s[8:11], s1 offen offset:1024 lds
    s_add_u32 s63, s63, 1
    s_and_b32 s63, s63, 7
    s_waitcnt lgkmcnt(10)
    v_mfma_f32_32x32x16_bf16 v[80:95], a[32:35], v[32:35], v[80:95]
    ds_read_b128 a[44:47], v14 offset:32768
    ds_read_b64_tr_b16 v[52:53], v17 offset:6144
    ds_read_b64_tr_b16 v[54:55], v17 offset:6656
    s_add_u32 m0, s62, 20480
    s_mul_i32 s1, s0, 176128
    buffer_load_dwordx4 v7, s[16:19], s1 offen offset:0 lds
    buffer_load_dwordx4 v8, s[16:19], s1 offen offset:1024 lds
    s_waitcnt lgkmcnt(10)
    v_mfma_f32_32x32x16_bf16 v[64:79], a[36:39], v[36:39], v[64:79]
    ds_read_b64_tr_b16 v[56:57], v18 offset:6144
    ds_read_b64_tr_b16 v[58:59], v18 offset:6656
    buffer_load_dwordx4 v9, s[16:19], s1 offen offset:2048 lds
    s_add_u32 s0, s0, 1
    s_and_b32 s0, s0, 7
    s_waitcnt lgkmcnt(10)
    v_mfma_f32_32x32x16_bf16 v[80:95], a[36:39], v[40:43], v[80:95]
    s_waitcnt vmcnt(9)
    s_barrier
    ds_read_b128 a[48:51], v11 offset:0
    ds_read_b64_tr_b16 v[28:29], v17 offset:20480
    ds_read_b64_tr_b16 v[30:31], v17 offset:20992
    s_waitcnt lgkmcnt(10)
    v_mfma_f32_32x32x16_bf16 v[64:79], a[40:43], v[44:47], v[64:79]
    ds_read_b64_tr_b16 v[32:33], v18 offset:20480
    ds_read_b64_tr_b16 v[34:35], v18 offset:20992
    s_waitcnt lgkmcnt(10)
    v_mfma_f32_32x32x16_bf16 v[80:95], a[40:43], v[48:51], v[80:95]
    ds_read_b64_tr_b16 v[36:37], v19 offset:0
    ds_read_b64_tr_b16 v[38:39], v19 offset:768
    s_waitcnt lgkmcnt(9)
    v_mfma_f32_32x32x16_bf16 v[64:79], a[44:47], v[52:55], v[64:79]
    ds_read_b64_tr_b16 v[40:41], v19 offset:64
    ds_read_b64_tr_b16 v[42:43], v19 offset:832
    s_add_u32 m0, s59, 32768
    s_lshl_b32 s1, s63, 7
    buffer_load_dwordx4 v1, s[4:7], s1 offen offset:0 lds
    s_waitcnt lgkmcnt(9)
    v_mfma_f32_32x32x16_bf16 v[80:95], a[44:47], v[56:59], v[80:95]
    ds_read_b64_tr_b16 v[44:45], v19 offset:128
    ds_read_b64_tr_b16 v[46:47], v19 offset:896
    buffer_load_dwordx4 v2, s[4:7], s1 offen offset:1024 lds
    s_waitcnt lgkmcnt(8)
    v_mfma_f32_32x32x16_bf16 v[64:79], a[48:51], v[28:31], v[64:79]
    ds_read_b128 a[52:55], v12 offset:0
    ds_read_b64_tr_b16 v[48:49], v17 offset:22528
    ds_read_b64_tr_b16 v[50:51], v17 offset:23040
    s_waitcnt lgkmcnt(9)
    v_mfma_f32_32x32x16_bf16 v[80:95], a[48:51], v[32:35], v[80:95]
    ds_read_b64_tr_b16 v[52:53], v18 offset:22528
    ds_read_b64_tr_b16 v[54:55], v18 offset:23040
    buffer_load_dwordx4 v3, s[4:7], s1 offen offset:2048 lds
    s_waitcnt lgkmcnt(9)
    v_mfma_f32_32x32x16_bf16 v[112:127], v[36:39], a[0:3], v[112:127]
    ds_read_b64_tr_b16 v[56:57], v19 offset:3072
    ds_read_b64_tr_b16 v[58:59], v19 offset:3840
    s_waitcnt lgkmcnt(9)
    v_mfma_f32_32x32x16_bf16 v[128:143], v[40:43], a[0:3], v[128:143]
    ds_read_b64_tr_b16 v[28:29], v19 offset:3136
    ds_read_b64_tr_b16 v[30:31], v19 offset:3904
    buffer_load_dwordx4 v4, s[4:7], s1 offen offset:3072 lds
    s_waitcnt lgkmcnt(9)
    v_mfma_f32_32x32x16_bf16 v[144:159], v[44:47], a[0:3], v[144:159]
    ds_read_b64_tr_b16 v[32:33], v19 offset:3200
    ds_read_b64_tr_b16 v[34:35], v19 offset:3968
    s_waitcnt lgkmcnt(8)
    v_mfma_f32_32x32x16_bf16 v[64:79], a[52:55], v[48:51], v[64:79]
    ds_read_b128 a[56:59], v13 offset:0
    ds_read_b64_tr_b16 v[36:37], v17 offset:24576
    ds_read_b64_tr_b16 v[38:39], v17 offset:25088
    s_add_u32 m0, s60, 20480
    s_mul_i32 s1, s63, 196608
    buffer_load_dwordx4 v5, s[8:11], s1 offen offset:0 lds
    s_waitcnt lgkmcnt(9)
    v_mfma_f32_32x32x16_bf16 v[80:95], a[52:55], v[52:55], v[80:95]
    ds_read_b64_tr_b16 v[40:41], v18 offset:24576
    ds_read_b64_tr_b16 v[42:43], v18 offset:25088
    s_waitcnt lgkmcnt(9)
    v_mfma_f32_32x32x16_bf16 v[112:127], v[56:59], a[4:7], v[112:127]
    ds_read_b64_tr_b16 v[44:45], v19 offset:6144
    ds_read_b64_tr_b16 v[46:47], v19 offset:6912
    buffer_load_dwordx4 v6, s[8:11], s1 offen offset:1024 lds
    s_add_u32 s63, s63, 1
    s_and_b32 s63, s63, 7
    s_waitcnt lgkmcnt(9)
    v_mfma_f32_32x32x16_bf16 v[128:143], v[28:31], a[4:7], v[128:143]
    ds_read_b64_tr_b16 v[48:49], v19 offset:6208
    ds_read_b64_tr_b16 v[50:51], v19 offset:6976
    s_waitcnt lgkmcnt(9)
    v_mfma_f32_32x32x16_bf16 v[144:159], v[32:35], a[4:7], v[144:159]
    ds_read_b64_tr_b16 v[52:53], v19 offset:6272
    ds_read_b64_tr_b16 v[54:55], v19 offset:7040
    s_add_u32 m0, s62, 40960
    s_mul_i32 s1, s0, 176128
    buffer_load_dwordx4 v7, s[16:19], s1 offen offset:0 lds
    s_waitcnt lgkmcnt(8)
    v_mfma_f32_32x32x16_bf16 v[64:79], a[56:59], v[36:39], v[64:79]
    ds_read_b128 a[60:63], v14 offset:0
    ds_read_b64_tr_b16 v[56:57], v17 offset:26624
    ds_read_b64_tr_b16 v[58:59], v17 offset:27136
    s_waitcnt lgkmcnt(9)
    v_mfma_f32_32x32x16_bf16 v[80:95], a[56:59], v[40:43], v[80:95]
    ds_read_b64_tr_b16 v[28:29], v18 offset:26624
    ds_read_b64_tr_b16 v[30:31], v18 offset:27136
    buffer_load_dwordx4 v8, s[16:19], s1 offen offset:1024 lds
    s_waitcnt lgkmcnt(9)
    v_mfma_f32_32x32x16_bf16 v[112:127], v[44:47], a[8:11], v[112:127]
    ds_read_b64_tr_b16 v[32:33], v19 offset:9216
    ds_read_b64_tr_b16 v[34:35], v19 offset:9984
    s_waitcnt lgkmcnt(9)
    v_mfma_f32_32x32x16_bf16 v[128:143], v[48:51], a[8:11], v[128:143]
    ds_read_b64_tr_b16 v[36:37], v19 offset:9280
    ds_read_b64_tr_b16 v[38:39], v19 offset:10048
    buffer_load_dwordx4 v9, s[16:19], s1 offen offset:2048 lds
    s_add_u32 s0, s0, 1
    s_and_b32 s0, s0, 7
    s_waitcnt lgkmcnt(9)
    v_mfma_f32_32x32x16_bf16 v[144:159], v[52:55], a[8:11], v[144:159]
    ds_read_b64_tr_b16 v[40:41], v19 offset:9344
    ds_read_b64_tr_b16 v[42:43], v19 offset:10112
    s_waitcnt lgkmcnt(8)
    v_mfma_f32_32x32x16_bf16 v[64:79], a[60:63], v[56:59], v[64:79]
    s_waitcnt vmcnt(9)
    s_barrier
    ds_read_b128 a[64:67], v11 offset:16384
    ds_read_b64_tr_b16 v[44:45], v15 offset:0
    ds_read_b64_tr_b16 v[46:47], v15 offset:512
    buffer_load_dwordx4 v[100:103], v60, s[4:7], s70 offen offset:0
    buffer_load_dwordx4 v[104:107], v60, s[4:7], s70 offen offset:1024
    s_waitcnt lgkmcnt(9)
    v_mfma_f32_32x32x16_bf16 v[80:95], a[60:63], v[28:31], v[80:95]
    ds_read_b64_tr_b16 v[48:49], v16 offset:0
    ds_read_b64_tr_b16 v[50:51], v16 offset:512
    s_add_u32 m0, s59, 0
    s_lshl_b32 s1, s63, 7
    buffer_load_dwordx4 v1, s[4:7], s1 offen offset:0 lds
    s_waitcnt lgkmcnt(9)
    v_mfma_f32_32x32x16_bf16 v[112:127], v[32:35], a[12:15], v[112:127]
    ds_read_b64_tr_b16 v[52:53], v19 offset:20480
    ds_read_b64_tr_b16 v[54:55], v19 offset:21248
    s_waitcnt lgkmcnt(9)
    v_mfma_f32_32x32x16_bf16 v[128:143], v[36:39], a[12:15], v[128:143]
    ds_read_b64_tr_b16 v[56:57], v19 offset:20544
    ds_read_b64_tr_b16 v[58:59], v19 offset:21312
    buffer_load_dwordx4 v2, s[4:7], s1 offen offset:1024 lds
    s_waitcnt lgkmcnt(9)
    v_mfma_f32_32x32x16_bf16 v[144:159], v[40:43], a[12:15], v[144:159]
    ds_read_b64_tr_b16 v[28:29], v19 offset:20608
    ds_read_b64_tr_b16 v[30:31], v19 offset:21376
    s_waitcnt lgkmcnt(8)
    v_mfma_f32_32x32x16_bf16 v[64:79], a[64:67], v[44:47], v[64:79]
    ds_read_b128 a[68:71], v12 offset:16384
    ds_read_b64_tr_b16 v[32:33], v15 offset:2048
    ds_read_b64_tr_b16 v[34:35], v15 offset:2560
    buffer_load_dwordx4 v3, s[4:7], s1 offen offset:2048 lds
    s_waitcnt lgkmcnt(9)
    v_mfma_f32_32x32x16_bf16 v[80:95], a[64:67], v[48:51], v[80:95]
    ds_read_b64_tr_b16 v[36:37], v16 offset:2048
    ds_read_b64_tr_b16 v[38:39], v16 offset:2560
    s_waitcnt lgkmcnt(9)
    v_mfma_f32_32x32x16_bf16 v[112:127], v[52:55], a[16:19], v[112:127]
    ds_read_b64_tr_b16 v[40:41], v19 offset:23552
    ds_read_b64_tr_b16 v[42:43], v19 offset:24320
    buffer_load_dwordx4 v4, s[4:7], s1 offen offset:3072 lds
    s_waitcnt lgkmcnt(9)
    v_mfma_f32_32x32x16_bf16 v[128:143], v[56:59], a[16:19], v[128:143]
    ds_read_b64_tr_b16 v[44:45], v19 offset:23616
    ds_read_b64_tr_b16 v[46:47], v19 offset:24384
    s_waitcnt lgkmcnt(9)
    v_mfma_f32_32x32x16_bf16 v[144:159], v[28:31], a[16:19], v[144:159]
    ds_read_b64_tr_b16 v[48:49], v19 offset:23680
    ds_read_b64_tr_b16 v[50:51], v19 offset:24448
    s_add_u32 m0, s60, 40960
    s_mul_i32 s1, s63, 196608
    buffer_load_dwordx4 v5, s[8:11], s1 offen offset:0 lds
    s_waitcnt lgkmcnt(8)
    v_mfma_f32_32x32x16_bf16 v[64:79], a[68:71], v[32:35], v[64:79]
    ds_read_b128 a[72:75], v13 offset:16384
    ds_read_b64_tr_b16 v[52:53], v15 offset:4096
    ds_read_b64_tr_b16 v[54:55], v15 offset:4608
    s_waitcnt lgkmcnt(9)
    v_mfma_f32_32x32x16_bf16 v[80:95], a[68:71], v[36:39], v[80:95]
    ds_read_b64_tr_b16 v[56:57], v16 offset:4096
    ds_read_b64_tr_b16 v[58:59], v16 offset:4608
    buffer_load_dwordx4 v6, s[8:11], s1 offen offset:1024 lds
    s_add_u32 s63, s63, 1
    s_and_b32 s63, s63, 7
    s_waitcnt lgkmcnt(9)
    v_mfma_f32_32x32x16_bf16 v[112:127], v[40:43], a[20:23], v[112:127]
    ds_read_b64_tr_b16 v[28:29], v19 offset:26624
    ds_read_b64_tr_b16 v[30:31], v19 offset:27392
    s_waitcnt lgkmcnt(9)
    v_mfma_f32_32x32x16_bf16 v[128:143], v[44:47], a[20:23], v[128:143]
    ds_read_b64_tr_b16 v[32:33], v19 offset:26688
    ds_read_b64_tr_b16 v[34:35], v19 offset:27456
    s_add_u32 m0, s62, 61440
    s_mul_i32 s1, s0, 176128
    buffer_load_dwordx4 v7, s[16:19], s1 offen offset:0 lds
    s_waitcnt lgkmcnt(9)
    v_mfma_f32_32x32x16_bf16 v[144:159], v[48:51], a[20:23], v[144:159]
    ds_read_b64_tr_b16 v[36:37], v19 offset:26752
    ds_read_b64_tr_b16 v[38:39], v19 offset:27520
    s_waitcnt lgkmcnt(8)
    v_mfma_f32_32x32x16_bf16 v[64:79], a[72:75], v[52:55], v[64:79]
    ds_read_b128 a[76:79], v14 offset:16384
    ds_read_b64_tr_b16 v[40:41], v15 offset:6144
    ds_read_b64_tr_b16 v[42:43], v15 offset:6656
    buffer_load_dwordx4 v8, s[16:19], s1 offen offset:1024 lds
    s_waitcnt lgkmcnt(9)
    v_mfma_f32_32x32x16_bf16 v[80:95], a[72:75], v[56:59], v[80:95]
    ds_read_b64_tr_b16 v[44:45], v16 offset:6144
    ds_read_b64_tr_b16 v[46:47], v16 offset:6656
    s_waitcnt lgkmcnt(9)
    v_mfma_f32_32x32x16_bf16 v[112:127], v[28:31], a[24:27], v[112:127]
    ds_read_b64_tr_b16 v[48:49], v19 offset:29696
    ds_read_b64_tr_b16 v[50:51], v19 offset:30464
    buffer_load_dwordx4 v9, s[16:19], s1 offen offset:2048 lds
    s_add_u32 s0, s0, 1
    s_and_b32 s0, s0, 7
    s_waitcnt lgkmcnt(9)
    v_mfma_f32_32x32x16_bf16 v[128:143], v[32:35], a[24:27], v[128:143]
    ds_read_b64_tr_b16 v[52:53], v19 offset:29760
    ds_read_b64_tr_b16 v[54:55], v19 offset:30528
    s_waitcnt lgkmcnt(9)
    v_mfma_f32_32x32x16_bf16 v[144:159], v[36:39], a[24:27], v[144:159]
    ds_read_b64_tr_b16 v[56:57], v19 offset:29824
    ds_read_b64_tr_b16 v[58:59], v19 offset:30592
    s_waitcnt lgkmcnt(8)
    v_mfma_f32_32x32x16_bf16 v[64:79], a[76:79], v[40:43], v[64:79]
    s_waitcnt vmcnt(11)
    s_barrier
    ds_read_b128 a[80:83], v11 offset:32768
    ds_read_b64_tr_b16 v[28:29], v15 offset:20480
    ds_read_b64_tr_b16 v[30:31], v15 offset:20992
    s_waitcnt lgkmcnt(9)
    v_mfma_f32_32x32x16_bf16 v[80:95], a[76:79], v[44:47], v[80:95]
    ds_read_b64_tr_b16 v[32:33], v16 offset:20480
    ds_read_b64_tr_b16 v[34:35], v16 offset:20992
    s_add_u32 m0, s59, 16384
    s_lshl_b32 s1, s63, 7
    buffer_load_dwordx4 v1, s[4:7], s1 offen offset:0 lds
    s_waitcnt lgkmcnt(9)
    v_mfma_f32_32x32x16_bf16 v[112:127], v[48:51], a[28:31], v[112:127]
    ds_read_b64_tr_b16 v[36:37], v20 offset:0
    ds_read_b64_tr_b16 v[38:39], v20 offset:768
    s_waitcnt lgkmcnt(9)
    v_mfma_f32_32x32x16_bf16 v[128:143], v[52:55], a[28:31], v[128:143]
    ds_read_b64_tr_b16 v[40:41], v20 offset:64
    ds_read_b64_tr_b16 v[42:43], v20 offset:832
    buffer_load_dwordx4 v2, s[4:7], s1 offen offset:1024 lds
    s_waitcnt lgkmcnt(9)
    v_mfma_f32_32x32x16_bf16 v[144:159], v[56:59], a[28:31], v[144:159]
    ds_read_b64_tr_b16 v[44:45], v20 offset:128
    ds_read_b64_tr_b16 v[46:47], v20 offset:896
    s_waitcnt lgkmcnt(8)
    v_mfma_f32_32x32x16_bf16 v[64:79], a[80:83], v[28:31], v[64:79]
    ds_read_b128 a[84:87], v12 offset:32768
    ds_read_b64_tr_b16 v[48:49], v15 offset:22528
    ds_read_b64_tr_b16 v[50:51], v15 offset:23040
    buffer_load_dwordx4 v3, s[4:7], s1 offen offset:2048 lds
    s_waitcnt lgkmcnt(9)
    v_mfma_f32_32x32x16_bf16 v[80:95], a[80:83], v[32:35], v[80:95]
    ds_read_b64_tr_b16 v[52:53], v16 offset:22528
    ds_read_b64_tr_b16 v[54:55], v16 offset:23040
    s_waitcnt lgkmcnt(9)
    v_mfma_f32_32x32x16_bf16 v[112:127], v[36:39], a[32:35], v[112:127]
    ds_read_b64_tr_b16 v[56:57], v20 offset:3072
    ds_read_b64_tr_b16 v[58:59], v20 offset:3840
    buffer_load_dwordx4 v4, s[4:7], s1 offen offset:3072 lds
    s_waitcnt lgkmcnt(9)
    v_mfma_f32_32x32x16_bf16 v[128:143], v[40:43], a[32:35], v[128:143]
    ds_read_b64_tr_b16 v[28:29], v20 offset:3136
    ds_read_b64_tr_b16 v[30:31], v20 offset:3904
    s_waitcnt lgkmcnt(9)
    v_mfma_f32_32x32x16_bf16 v[144:159], v[44:47], a[32:35], v[144:159]
    ds_read_b64_tr_b16 v[32:33], v20 offset:3200
    ds_read_b64_tr_b16 v[34:35], v20 offset:3968
    s_add_u32 m0, s60, 61440
    s_mul_i32 s1, s63, 196608
    buffer_load_dwordx4 v5, s[8:11], s1 offen offset:0 lds
    s_waitcnt lgkmcnt(8)
    v_mfma_f32_32x32x16_bf16 v[64:79], a[84:87], v[48:51], v[64:79]
    ds_read_b128 a[88:91], v13 offset:32768
    ds_read_b64_tr_b16 v[36:37], v15 offset:24576
    ds_read_b64_tr_b16 v[38:39], v15 offset:25088
    s_waitcnt lgkmcnt(9)
    v_mfma_f32_32x32x16_bf16 v[80:95], a[84:87], v[52:55], v[80:95]
    ds_read_b64_tr_b16 v[40:41], v16 offset:24576
    ds_read_b64_tr_b16 v[42:43], v16 offset:25088
    buffer_load_dwordx4 v6, s[8:11], s1 offen offset:1024 lds
    s_add_u32 s63, s63, 1
    s_and_b32 s63, s63, 7
    s_waitcnt lgkmcnt(9)
    v_mfma_f32_32x32x16_bf16 v[112:127], v[56:59], a[36:39], v[112:127]
    ds_read_b64_tr_b16 v[44:45], v20 offset:6144
    ds_read_b64_tr_b16 v[46:47], v20 offset:6912
    s_waitcnt lgkmcnt(9)
    v_mfma_f32_32x32x16_bf16 v[128:143], v[28:31], a[36:39], v[128:143]
    ds_read_b64_tr_b16 v[48:49], v20 offset:6208
    ds_read_b64_tr_b16 v[50:51], v20 offset:6976
    s_add_u32 m0, s62, 0
    s_mul_i32 s1, s0, 176128
    buffer_load_dwordx4 v7, s[16:19], s1 offen offset:0 lds
    s_waitcnt lgkmcnt(9)
    v_mfma_f32_32x32x16_bf16 v[144:159], v[32:35], a[36:39], v[144:159]
    ds_read_b64_tr_b16 v[52:53], v20 offset:6272
    ds_read_b64_tr_b16 v[54:55], v20 offset:7040
    s_waitcnt lgkmcnt(8)
    v_mfma_f32_32x32x16_bf16 v[64:79], a[88:91], v[36:39], v[64:79]
    ds_read_b128 a[92:95], v14 offset:32768
    ds_read_b64_tr_b16 v[56:57], v15 offset:26624
    ds_read_b64_tr_b16 v[58:59], v15 offset:27136
    buffer_load_dwordx4 v8, s[16:19], s1 offen offset:1024 lds
    s_waitcnt lgkmcnt(9)
    v_mfma_f32_32x32x16_bf16 v[80:95], a[88:91], v[40:43], v[80:95]
    ds_read_b64_tr_b16 v[28:29], v16 offset:26624
    ds_read_b64_tr_b16 v[30:31], v16 offset:27136
    s_waitcnt lgkmcnt(9)
    v_mfma_f32_32x32x16_bf16 v[112:127], v[44:47], a[40:43], v[112:127]
    ds_read_b64_tr_b16 v[32:33], v20 offset:9216
    ds_read_b64_tr_b16 v[34:35], v20 offset:9984
    buffer_load_dwordx4 v9, s[16:19], s1 offen offset:2048 lds
    s_add_u32 s0, s0, 1
    s_and_b32 s0, s0, 7
    s_waitcnt lgkmcnt(9)
    v_mfma_f32_32x32x16_bf16 v[128:143], v[48:51], a[40:43], v[128:143]
    ds_read_b64_tr_b16 v[36:37], v20 offset:9280
    ds_read_b64_tr_b16 v[38:39], v20 offset:10048
    s_waitcnt lgkmcnt(9)
    v_mfma_f32_32x32x16_bf16 v[144:159], v[52:55], a[40:43], v[144:159]
    ds_read_b64_tr_b16 v[40:41], v20 offset:9344
    ds_read_b64_tr_b16 v[42:43], v20 offset:10112
    s_waitcnt lgkmcnt(8)
    v_mfma_f32_32x32x16_bf16 v[64:79], a[92:95], v[56:59], v[64:79]
    s_waitcnt vmcnt(9)
    s_barrier
    ds_read_b128 a[96:99], v11 offset:0
    ds_read_b64_tr_b16 v[44:45], v17 offset:0
    ds_read_b64_tr_b16 v[46:47], v17 offset:512
    s_waitcnt lgkmcnt(9)
    v_mfma_f32_32x32x16_bf16 v[80:95], a[92:95], v[28:31], v[80:95]
    ds_read_b64_tr_b16 v[48:49], v18 offset:0
    ds_read_b64_tr_b16 v[50:51], v18 offset:512
    s_add_u32 m0, s62, 20480
    s_mul_i32 s1, s0, 176128
    buffer_load_dwordx4 v7, s[16:19], s1 offen offset:0 lds
    s_waitcnt lgkmcnt(9)
    v_mfma_f32_32x32x16_bf16 v[112:127], v[32:35], a[44:47], v[112:127]
    ds_read_b64_tr_b16 v[52:53], v20 offset:20480
    ds_read_b64_tr_b16 v[54:55], v20 offset:21248
    v_mov_b32 v24, 0
    v_mov_b32 v25, 0
    s_waitcnt lgkmcnt(9)
    v_mfma_f32_32x32x16_bf16 v[128:143], v[36:39], a[44:47], v[128:143]
    ds_read_b64_tr_b16 v[56:57], v20 offset:20544
    ds_read_b64_tr_b16 v[58:59], v20 offset:21312
    v_dot2c_f32_bf16 v24, v100, v96
    v_dot2c_f32_bf16 v25, v104, v96
    s_waitcnt lgkmcnt(9)
    v_mfma_f32_32x32x16_bf16 v[144:159], v[40:43], a[44:47], v[144:159]
    ds_read_b64_tr_b16 v[28:29], v20 offset:20608
    ds_read_b64_tr_b16 v[30:31], v20 offset:21376
    buffer_load_dwordx4 v8, s[16:19], s1 offen offset:1024 lds
    v_dot2c_f32_bf16 v24, v101, v97
    v_dot2c_f32_bf16 v25, v105, v97
    s_waitcnt lgkmcnt(8)
    v_mfma_f32_32x32x16_bf16 v[64:79], a[96:99], v[44:47], v[64:79]
    ds_read_b128 a[100:103], v12 offset:0
    ds_read_b64_tr_b16 v[32:33], v17 offset:2048
    ds_read_b64_tr_b16 v[34:35], v17 offset:2560
    v_dot2c_f32_bf16 v24, v102, v98
    v_dot2c_f32_bf16 v25, v106, v98
    s_waitcnt lgkmcnt(9)
    v_mfma_f32_32x32x16_bf16 v[80:95], a[96:99], v[48:51], v[80:95]
    ds_read_b64_tr_b16 v[36:37], v18 offset:2048
    ds_read_b64_tr_b16 v[38:39], v18 offset:2560
    v_dot2c_f32_bf16 v24, v103, v99
    v_dot2c_f32_bf16 v25, v107, v99
    s_waitcnt lgkmcnt(9)
    v_mfma_f32_32x32x16_bf16 v[112:127], v[52:55], a[48:51], v[112:127]
    ds_read_b64_tr_b16 v[40:41], v20 offset:23552
    ds_read_b64_tr_b16 v[42:43], v20 offset:24320
    buffer_load_dwordx4 v9, s[16:19], s1 offen offset:2048 lds
    s_add_u32 s0, s0, 1
    s_and_b32 s0, s0, 7
    v_add_f32_dpp v24, v24, v24 row_shr:1
    v_add_f32_dpp v25, v25, v25 row_shr:1
    s_waitcnt lgkmcnt(9)
    v_mfma_f32_32x32x16_bf16 v[128:143], v[56:59], a[48:51], v[128:143]
    ds_read_b64_tr_b16 v[44:45], v20 offset:23616
    ds_read_b64_tr_b16 v[46:47], v20 offset:24384
    v_add_f32_dpp v24, v24, v24 row_shr:2
    v_add_f32_dpp v25, v25, v25 row_shr:2
    s_waitcnt lgkmcnt(9)
    v_mfma_f32_32x32x16_bf16 v[144:159], v[28:31], a[48:51], v[144:159]
    ds_read_b64_tr_b16 v[48:49], v20 offset:23680
    ds_read_b64_tr_b16 v[50:51], v20 offset:24448
    v_add_f32_dpp v24, v24, v24 row_shr:4
    v_add_f32_dpp v25, v25, v25 row_shr:4
    s_waitcnt lgkmcnt(8)
    v_mfma_f32_32x32x16_bf16 v[64:79], a[100:103], v[32:35], v[64:79]
    ds_read_b128 a[104:107], v13 offset:0
    ds_read_b64_tr_b16 v[52:53], v17 offset:4096
    ds_read_b64_tr_b16 v[54:55], v17 offset:4608
    s_add_u32 m0, s61, 4096
    s_mul_i32 s1, s64, 196608
    buffer_load_dwordx4 v10, s[8:11], s1 offen lds
    s_add_u32 s64, s64, 1
    s_and_b32 s64, s64, 7
    v_add_f32_dpp v24, v24, v24 row_shr:8
    v_add_f32_dpp v25, v25, v25 row_shr:8
    s_waitcnt lgkmcnt(9)
    v_mfma_f32_32x32x16_bf16 v[80:95], a[100:103], v[36:39], v[80:95]
    ds_read_b64_tr_b16 v[56:57], v18 offset:4096
    ds_read_b64_tr_b16 v[58:59], v18 offset:4608
    v_add_f32_dpp v24, v24, v24 row_bcast:15 row_mask:0xa
    v_add_f32_dpp v25, v25, v25 row_bcast:15 row_mask:0xa
    s_waitcnt lgkmcnt(9)
    v_mfma_f32_32x32x16_bf16 v[112:127], v[40:43], a[52:55], v[112:127]
    ds_read_b64_tr_b16 v[28:29], v20 offset:26624
    ds_read_b64_tr_b16 v[30:31], v20 offset:27392
    v_add_f32_dpp v24, v24, v24 row_bcast:31 row_mask:0xc
    v_add_f32_dpp v25, v25, v25 row_bcast:31 row_mask:0xc
    s_waitcnt lgkmcnt(9)
    v_mfma_f32_32x32x16_bf16 v[128:143], v[44:47], a[52:55], v[128:143]
    ds_read_b64_tr_b16 v[32:33], v20 offset:26688
    ds_read_b64_tr_b16 v[34:35], v20 offset:27456
    s_add_u32 m0, s61, 8192
    s_mul_i32 s1, s64, 196608
    buffer_load_dwordx4 v10, s[8:11], s1 offen lds
    s_add_u32 s64, s64, 1
    s_and_b32 s64, s64, 7
    v_mul_f32 v24, 0xbfb8aa3b, v24
    v_mul_f32 v25, 0xbfb8aa3b, v25
    s_waitcnt lgkmcnt(9)
    v_mfma_f32_32x32x16_bf16 v[144:159], v[48:51], a[52:55], v[144:159]
    ds_read_b64_tr_b16 v[36:37], v20 offset:26752
    ds_read_b64_tr_b16 v[38:39], v20 offset:27520
    v_exp_f32_e64 v24, v24
    v_exp_f32 v25, v25
    s_waitcnt lgkmcnt(8)
    v_mfma_f32_32x32x16_bf16 v[64:79], a[104:107], v[52:55], v[64:79]
    ds_read_b128 a[108:111], v14 offset:0
    ds_read_b64_tr_b16 v[40:41], v17 offset:6144
    ds_read_b64_tr_b16 v[42:43], v17 offset:6656
    v_add_f32_e64 v24, 1.0, v24
    v_add_f32 v25, 1.0, v25
    s_waitcnt lgkmcnt(9)
    v_mfma_f32_32x32x16_bf16 v[80:95], a[104:107], v[56:59], v[80:95]
    ds_read_b64_tr_b16 v[44:45], v18 offset:6144
    ds_read_b64_tr_b16 v[46:47], v18 offset:6656
    s_add_u32 m0, s61, 12288
    s_mul_i32 s1, s64, 196608
    buffer_load_dwordx4 v10, s[8:11], s1 offen lds
    s_add_u32 s64, s64, 1
    s_and_b32 s64, s64, 7
    v_rcp_f32_e64 v24, v24
    v_rcp_f32 v25, v25
    s_waitcnt lgkmcnt(9)
    v_mfma_f32_32x32x16_bf16 v[112:127], v[28:31], a[56:59], v[112:127]
    ds_read_b64_tr_b16 v[48:49], v20 offset:29696
    ds_read_b64_tr_b16 v[50:51], v20 offset:30464
    s_waitcnt lgkmcnt(9)
    v_mfma_f32_32x32x16_bf16 v[128:143], v[32:35], a[56:59], v[128:143]
    ds_read_b64_tr_b16 v[52:53], v20 offset:29760
    ds_read_b64_tr_b16 v[54:55], v20 offset:30528
    s_waitcnt lgkmcnt(9)
    v_mfma_f32_32x32x16_bf16 v[144:159], v[36:39], a[56:59], v[144:159]
    ds_read_b64_tr_b16 v[56:57], v20 offset:29824
    ds_read_b64_tr_b16 v[58:59], v20 offset:30592
    s_waitcnt lgkmcnt(8)
    v_mfma_f32_32x32x16_bf16 v[64:79], a[108:111], v[40:43], v[64:79]
    s_waitcnt vmcnt(6)
    s_barrier
    ds_read_b128 a[112:115], v11 offset:16384
    ds_read_b64_tr_b16 v[28:29], v17 offset:20480
    ds_read_b64_tr_b16 v[30:31], v17 offset:20992
    s_waitcnt lgkmcnt(9)
    v_mfma_f32_32x32x16_bf16 v[80:95], a[108:111], v[44:47], v[80:95]
    ds_read_b64_tr_b16 v[32:33], v18 offset:20480
    ds_read_b64_tr_b16 v[34:35], v18 offset:20992
    s_add_u32 m0, s62, 40960
    s_mul_i32 s1, s0, 176128
    buffer_load_dwordx4 v7, s[16:19], s1 offen offset:0 lds
    s_waitcnt lgkmcnt(9)
    v_mfma_f32_32x32x16_bf16 v[112:127], v[48:51], a[60:63], v[112:127]
    ds_read_b128 a[116:119], v12 offset:16384
    ds_read_b64_tr_b16 v[36:37], v17 offset:22528
    ds_read_b64_tr_b16 v[38:39], v17 offset:23040
    s_waitcnt lgkmcnt(10)
    v_mfma_f32_32x32x16_bf16 v[128:143], v[52:55], a[60:63], v[128:143]
    ds_read_b64_tr_b16 v[40:41], v18 offset:22528
    ds_read_b64_tr_b16 v[42:43], v18 offset:23040
    s_waitcnt lgkmcnt(10)
    v_mfma_f32_32x32x16_bf16 v[144:159], v[56:59], a[60:63], v[144:159]
    ds_read_b128 a[120:123], v13 offset:16384
    ds_read_b64_tr_b16 v[44:45], v17 offset:24576
    ds_read_b64_tr_b16 v[46:47], v17 offset:25088
    s_add_u32 m0, s62, 40960
    s_nop 0
    buffer_load_dwordx4 v8, s[16:19], s1 offen offset:1024 lds
    s_waitcnt lgkmcnt(10)
    v_mfma_f32_32x32x16_bf16 v[64:79], a[112:115], v[28:31], v[64:79]
    ds_read_b64_tr_b16 v[48:49], v18 offset:24576
    ds_read_b64_tr_b16 v[50:51], v18 offset:25088
    s_waitcnt lgkmcnt(10)
    v_mfma_f32_32x32x16_bf16 v[80:95], a[112:115], v[32:35], v[80:95]
    ds_read_b128 a[124:127], v14 offset:16384
    ds_read_b64_tr_b16 v[52:53], v17 offset:26624
    ds_read_b64_tr_b16 v[54:55], v17 offset:27136
    s_waitcnt lgkmcnt(10)
    v_mfma_f32_32x32x16_bf16 v[64:79], a[116:119], v[36:39], v[64:79]
    ds_read_b64_tr_b16 v[56:57], v18 offset:26624
    ds_read_b64_tr_b16 v[58:59], v18 offset:27136
    s_add_u32 m0, s62, 40960
    s_nop 0
    buffer_load_dwordx4 v9, s[16:19], s1 offen offset:2048 lds
    s_add_u32 s0, s0, 1
    s_and_b32 s0, s0, 7
    s_waitcnt lgkmcnt(10)
    v_mfma_f32_32x32x16_bf16 v[80:95], a[116:119], v[40:43], v[80:95]
    ds_read_b64_tr_b16 v[28:29], v19 offset:0
    ds_read_b64_tr_b16 v[30:31], v19 offset:768
    s_waitcnt lgkmcnt(9)
    v_mfma_f32_32x32x16_bf16 v[64:79], a[120:123], v[44:47], v[64:79]
    ds_read_b64_tr_b16 v[32:33], v19 offset:64
    ds_read_b64_tr_b16 v[34:35], v19 offset:832
    s_waitcnt lgkmcnt(9)
    v_mfma_f32_32x32x16_bf16 v[80:95], a[120:123], v[48:51], v[80:95]
    ds_read_b64_tr_b16 v[36:37], v19 offset:128
    ds_read_b64_tr_b16 v[38:39], v19 offset:896
    s_add_u32 m0, s61, 16384
    s_mul_i32 s1, s64, 196608
    buffer_load_dwordx4 v10, s[8:11], s1 offen lds
    s_add_u32 s64, s64, 1
    s_and_b32 s64, s64, 7
    s_waitcnt lgkmcnt(8)
    v_mfma_f32_32x32x16_bf16 v[64:79], a[124:127], v[52:55], v[64:79]
    ds_read_b64_tr_b16 v[40:41], v19 offset:3072
    ds_read_b64_tr_b16 v[42:43], v19 offset:3840
    s_waitcnt lgkmcnt(8)
    v_mfma_f32_32x32x16_bf16 v[80:95], a[124:127], v[56:59], v[80:95]
    ds_read_b64_tr_b16 v[44:45], v19 offset:3136
    ds_read_b64_tr_b16 v[46:47], v19 offset:3904
PA_DONE:
    s_waitcnt lgkmcnt(8)
    v_mfma_f32_32x32x16_bf16 v[112:127], v[28:31], a[64:67], v[112:127]
    ds_read_b64_tr_b16 v[48:49], v19 offset:3200
    ds_read_b64_tr_b16 v[50:51], v19 offset:3968
    s_add_u32 m0, s61, 20480
    s_mul_i32 s1, s64, 196608
    buffer_load_dwordx4 v10, s[8:11], s1 offen lds
    s_add_u32 s64, s64, 1
    s_and_b32 s64, s64, 7
    s_waitcnt lgkmcnt(8)
    v_mfma_f32_32x32x16_bf16 v[128:143], v[32:35], a[64:67], v[128:143]
    ds_read_b64_tr_b16 v[52:53], v19 offset:6144
    ds_read_b64_tr_b16 v[54:55], v19 offset:6912
    s_waitcnt lgkmcnt(8)
    v_mfma_f32_32x32x16_bf16 v[144:159], v[36:39], a[64:67], v[144:159]
    ds_read_b64_tr_b16 v[56:57], v19 offset:6208
    ds_read_b64_tr_b16 v[58:59], v19 offset:6976
    v_cvt_pk_bf16_f32 v176, v64, v65
    v_cvt_pk_bf16_f32 v177, v66, v67
    v_cvt_pk_bf16_f32 v178, v68, v69
    s_waitcnt lgkmcnt(8)
    v_mfma_f32_32x32x16_bf16 v[112:127], v[40:43], a[68:71], v[112:127]
    ds_read_b64_tr_b16 v[28:29], v19 offset:6272
    ds_read_b64_tr_b16 v[30:31], v19 offset:7040
    s_add_u32 m0, s61, 24576
    s_mul_i32 s1, s64, 196608
    buffer_load_dwordx4 v10, s[8:11], s1 offen lds
    s_add_u32 s64, s64, 1
    s_and_b32 s64, s64, 7
    v_cvt_pk_bf16_f32 v179, v70, v71
    v_cvt_pk_bf16_f32 v180, v72, v73
    v_cvt_pk_bf16_f32 v181, v74, v75
    s_waitcnt lgkmcnt(8)
    v_mfma_f32_32x32x16_bf16 v[128:143], v[44:47], a[68:71], v[128:143]
    ds_read_b64_tr_b16 v[32:33], v19 offset:9216
    ds_read_b64_tr_b16 v[34:35], v19 offset:9984
    v_cvt_pk_bf16_f32 v182, v76, v77
    v_cvt_pk_bf16_f32 v183, v78, v79
    v_cvt_pk_bf16_f32 v184, v80, v81
    s_waitcnt lgkmcnt(8)
    v_mfma_f32_32x32x16_bf16 v[144:159], v[48:51], a[68:71], v[144:159]
    ds_read_b64_tr_b16 v[36:37], v19 offset:9280
    ds_read_b64_tr_b16 v[38:39], v19 offset:10048
    v_cvt_pk_bf16_f32 v185, v82, v83
    v_cvt_pk_bf16_f32 v186, v84, v85
    v_cvt_pk_bf16_f32 v187, v86, v87
    s_waitcnt lgkmcnt(8)
    v_mfma_f32_32x32x16_bf16 v[112:127], v[52:55], a[72:75], v[112:127]
    ds_read_b64_tr_b16 v[40:41], v19 offset:9344
    ds_read_b64_tr_b16 v[42:43], v19 offset:10112
    v_cvt_pk_bf16_f32 v188, v88, v89
    v_cvt_pk_bf16_f32 v189, v90, v91
    v_cvt_pk_bf16_f32 v190, v92, v93
    s_waitcnt lgkmcnt(8)
    v_mfma_f32_32x32x16_bf16 v[128:143], v[56:59], a[72:75], v[128:143]
    s_waitcnt vmcnt(9)
    s_barrier
    ds_read_b64_tr_b16 v[44:45], v19 offset:20480
    ds_read_b64_tr_b16 v[46:47], v19 offset:21248
    v_cvt_pk_bf16_f32 v191, v94, v95
    s_waitcnt lgkmcnt(8)
    v_mfma_f32_32x32x16_bf16 v[144:159], v[28:31], a[72:75], v[144:159]
    ds_read_b64_tr_b16 v[48:49], v19 offset:20544
    ds_read_b64_tr_b16 v[50:51], v19 offset:21312
    s_add_u32 m0, s62, 61440
    s_mul_i32 s1, s0, 176128
    buffer_load_dwordx4 v7, s[16:19], s1 offen offset:0 lds
    global_load_dword v207, v63, s[40:41] sc1
    s_waitcnt lgkmcnt(8)
    v_mfma_f32_32x32x16_bf16 v[112:127], v[32:35], a[76:79], v[112:127]
    ds_read_b64_tr_b16 v[52:53], v19 offset:20608
    ds_read_b64_tr_b16 v[54:55], v19 offset:21376
    s_add_u32 s56, s65, 0
    buffer_store_dwordx4 v[176:179], v202, s[36:39], s56 offen sc1
    s_add_u32 s56, s56, s66
    buffer_store_dwordx4 v[180:183], v202, s[36:39], s56 offen sc1
    s_add_u32 s56, s65, 131072
    buffer_store_dwordx4 v[184:187], v202, s[36:39], s56 offen sc1
    s_add_u32 s56, s56, s66
    buffer_store_dwordx4 v[188:191], v202, s[36:39], s56 offen sc1
    s_waitcnt lgkmcnt(8)
    v_mfma_f32_32x32x16_bf16 v[128:143], v[36:39], a[76:79], v[128:143]
    ds_read_b64_tr_b16 v[56:57], v19 offset:23552
    ds_read_b64_tr_b16 v[58:59], v19 offset:24320
    s_add_u32 m0, s62, 61440
    s_nop 0
    buffer_load_dwordx4 v8, s[16:19], s1 offen offset:1024 lds
    s_waitcnt lgkmcnt(8)
    v_mfma_f32_32x32x16_bf16 v[144:159], v[40:43], a[76:79], v[144:159]
    ds_read_b64_tr_b16 v[28:29], v19 offset:23616
    ds_read_b64_tr_b16 v[30:31], v19 offset:24384
    s_lshr_b32 s54, s3, 1
    s_lshl_b32 s54, s54, 13
    s_waitcnt lgkmcnt(8)
    v_mfma_f32_32x32x16_bf16 v[112:127], v[44:47], a[80:83], v[112:127]
    ds_read_b64_tr_b16 v[32:33], v19 offset:23680
    ds_read_b64_tr_b16 v[34:35], v19 offset:24448
    s_and_b32 s55, s3, 1
    s_lshl_b32 s55, s55, 10
    s_waitcnt lgkmcnt(8)
    v_mfma_f32_32x32x16_bf16 v[128:143], v[48:51], a[80:83], v[128:143]
    ds_read_b64_tr_b16 v[36:37], v19 offset:26624
    ds_read_b64_tr_b16 v[38:39], v19 offset:27392
    s_add_u32 m0, s62, 61440
    s_nop 0
    buffer_load_dwordx4 v9, s[16:19], s1 offen offset:2048 lds
    s_add_u32 s0, s0, 1
    s_and_b32 s0, s0, 7
    s_add_u32 s54, s54, s55
    s_add_u32 s54, s54, 81920
    s_waitcnt lgkmcnt(8)
    v_mfma_f32_32x32x16_bf16 v[144:159], v[52:55], a[80:83], v[144:159]
    ds_read_b64_tr_b16 v[40:41], v19 offset:26688
    ds_read_b64_tr_b16 v[42:43], v19 offset:27456
    v_add_u32 v21, s54, v60
    s_add_u32 s54, s59, 81920
    s_waitcnt lgkmcnt(8)
    v_mfma_f32_32x32x16_bf16 v[112:127], v[56:59], a[84:87], v[112:127]
    ds_read_b64_tr_b16 v[44:45], v19 offset:26752
    ds_read_b64_tr_b16 v[46:47], v19 offset:27520
    v_add_u32 v22, s54, v60
    s_waitcnt lgkmcnt(8)
    v_mfma_f32_32x32x16_bf16 v[128:143], v[28:31], a[84:87], v[128:143]
    ds_read_b64_tr_b16 v[48:49], v19 offset:29696
    ds_read_b64_tr_b16 v[50:51], v19 offset:30464
    s_add_u32 m0, s61, 28672
    s_mul_i32 s1, s64, 196608
    buffer_load_dwordx4 v10, s[8:11], s1 offen lds
    s_add_u32 s64, s64, 1
    s_and_b32 s64, s64, 7
    s_waitcnt lgkmcnt(8)
    v_mfma_f32_32x32x16_bf16 v[144:159], v[32:35], a[84:87], v[144:159]
    ds_read_b64_tr_b16 v[52:53], v19 offset:29760
    ds_read_b64_tr_b16 v[54:55], v19 offset:30528
    s_waitcnt lgkmcnt(8)
    v_mfma_f32_32x32x16_bf16 v[112:127], v[36:39], a[88:91], v[112:127]
    ds_read_b64_tr_b16 v[56:57], v19 offset:29824
    ds_read_b64_tr_b16 v[58:59], v19 offset:30592
    s_waitcnt lgkmcnt(8)
    v_mfma_f32_32x32x16_bf16 v[128:143], v[40:43], a[88:91], v[128:143]
    s_waitcnt vmcnt(12)
    s_barrier
    ds_read_b64_tr_b16 v[28:29], v20 offset:0
    ds_read_b64_tr_b16 v[30:31], v20 offset:768
    s_waitcnt lgkmcnt(8)
    v_mfma_f32_32x32x16_bf16 v[144:159], v[44:47], a[88:91], v[144:159]
    ds_read_b64_tr_b16 v[32:33], v20 offset:64
    ds_read_b64_tr_b16 v[34:35], v20 offset:832
    s_waitcnt lgkmcnt(8)
    v_mfma_f32_32x32x16_bf16 v[112:127], v[48:51], a[92:95], v[112:127]
    ds_read_b64_tr_b16 v[36:37], v20 offset:128
    ds_read_b64_tr_b16 v[38:39], v20 offset:896
    buffer_load_dword a248, v204, s[24:27], s86 offen
    s_waitcnt lgkmcnt(8)
    v_mfma_f32_32x32x16_bf16 v[128:143], v[52:55], a[92:95], v[128:143]
    ds_read_b64_tr_b16 v[40:41], v20 offset:3072
    ds_read_b64_tr_b16 v[42:43], v20 offset:3840
    buffer_load_dword a249, v205, s[12:15], s87 offen
    s_waitcnt lgkmcnt(8)
    v_mfma_f32_32x32x16_bf16 v[144:159], v[56:59], a[92:95], v[144:159]
    ds_read_b64_tr_b16 v[44:45], v20 offset:3136
    ds_read_b64_tr_b16 v[46:47], v20 offset:3904
    s_waitcnt lgkmcnt(8)
    v_mfma_f32_32x32x16_bf16 v[112:127], v[28:31], a[96:99], v[112:127]
    ds_read_b64_tr_b16 v[48:49], v20 offset:3200
    ds_read_b64_tr_b16 v[50:51], v20 offset:3968
    s_waitcnt lgkmcnt(8)
    v_mfma_f32_32x32x16_bf16 v[128:143], v[32:35], a[96:99], v[128:143]
    ds_read_b64_tr_b16 v[52:53], v20 offset:6144
    ds_read_b64_tr_b16 v[54:55], v20 offset:6912
    s_waitcnt lgkmcnt(8)
    v_mfma_f32_32x32x16_bf16 v[144:159], v[36:39], a[96:99], v[144:159]
    ds_read_b64_tr_b16 v[56:57], v20 offset:6208
    ds_read_b64_tr_b16 v[58:59], v20 offset:6976
    s_waitcnt lgkmcnt(8)
    v_mfma_f32_32x32x16_bf16 v[112:127], v[40:43], a[100:103], v[112:127]
    ds_read_b64_tr_b16 v[28:29], v20 offset:6272
    ds_read_b64_tr_b16 v[30:31], v20 offset:7040
    s_waitcnt lgkmcnt(8)
    v_mfma_f32_32x32x16_bf16 v[128:143], v[44:47], a[100:103], v[128:143]
    ds_read_b64_tr_b16 v[32:33], v20 offset:9216
    ds_read_b64_tr_b16 v[34:35], v20 offset:9984
    s_waitcnt lgkmcnt(8)
    v_mfma_f32_32x32x16_bf16 v[144:159], v[48:51], a[100:103], v[144:159]
    ds_read_b64_tr_b16 v[36:37], v20 offset:9280
    ds_read_b64_tr_b16 v[38:39], v20 offset:10048
    s_waitcnt lgkmcnt(8)
    v_mfma_f32_32x32x16_bf16 v[112:127], v[52:55], a[104:107], v[112:127]
    ds_read_b64_tr_b16 v[40:41], v20 offset:9344
    ds_read_b64_tr_b16 v[42:43], v20 offset:10112
    s_waitcnt lgkmcnt(8)
    v_mfma_f32_32x32x16_bf16 v[128:143], v[56:59], a[104:107], v[128:143]
    s_waitcnt vmcnt(3)
    s_barrier
    ds_read_b64_tr_b16 v[44:45], v20 offset:20480
    ds_read_b64_tr_b16 v[46:47], v20 offset:21248
    s_waitcnt lgkmcnt(8)
    v_mfma_f32_32x32x16_bf16 v[144:159], v[28:31], a[104:107], v[144:159]
    ds_read_b64_tr_b16 v[48:49], v20 offset:20544
    ds_read_b64_tr_b16 v[50:51], v20 offset:21312
    s_waitcnt lgkmcnt(8)
    v_mfma_f32_32x32x16_bf16 v[112:127], v[32:35], a[108:111], v[112:127]
    ds_read_b64_tr_b16 v[52:53], v20 offset:20608
    ds_read_b64_tr_b16 v[54:55], v20 offset:21376
    s_waitcnt lgkmcnt(8)
    v_mfma_f32_32x32x16_bf16 v[128:143], v[36:39], a[108:111], v[128:143]
    ds_read_b64_tr_b16 v[56:57], v20 offset:23552
    ds_read_b64_tr_b16 v[58:59], v20 offset:24320
    s_waitcnt lgkmcnt(8)
    v_mfma_f32_32x32x16_bf16 v[144:159], v[40:43], a[108:111], v[144:159]
    ds_read_b64_tr_b16 v[28:29], v20 offset:23616
    ds_read_b64_tr_b16 v[30:31], v20 offset:24384
    s_waitcnt lgkmcnt(8)
    v_mfma_f32_32x32x16_bf16 v[112:127], v[44:47], a[112:115], v[112:127]
    ds_read_b64_tr_b16 v[32:33], v20 offset:23680
    ds_read_b64_tr_b16 v[34:35], v20 offset:24448
    s_waitcnt lgkmcnt(8)
    v_mfma_f32_32x32x16_bf16 v[128:143], v[48:51], a[112:115], v[128:143]
    ds_read_b64_tr_b16 v[36:37], v20 offset:26624
    ds_read_b64_tr_b16 v[38:39], v20 offset:27392
    s_waitcnt lgkmcnt(8)
    v_mfma_f32_32x32x16_bf16 v[144:159], v[52:55], a[112:115], v[144:159]
    ds_read_b64_tr_b16 v[40:41], v20 offset:26688
    ds_read_b64_tr_b16 v[42:43], v20 offset:27456
    s_waitcnt lgkmcnt(8)
    v_mfma_f32_32x32x16_bf16 v[112:127], v[56:59], a[116:119], v[112:127]
    ds_read_b64_tr_b16 v[44:45], v20 offset:26752
    ds_read_b64_tr_b16 v[46:47], v20 offset:27520
    s_waitcnt lgkmcnt(8)
    v_mfma_f32_32x32x16_bf16 v[128:143], v[28:31], a[116:119], v[128:143]
    ds_read_b64_tr_b16 v[48:49], v20 offset:29696
    ds_read_b64_tr_b16 v[50:51], v20 offset:30464
    s_waitcnt lgkmcnt(8)
    v_mfma_f32_32x32x16_bf16 v[144:159], v[32:35], a[116:119], v[144:159]
    ds_read_b64_tr_b16 v[52:53], v20 offset:29760
    ds_read_b64_tr_b16 v[54:55], v20 offset:30528
    s_waitcnt lgkmcnt(8)
    v_mfma_f32_32x32x16_bf16 v[112:127], v[36:39], a[120:123], v[112:127]
    ds_read_b64_tr_b16 v[56:57], v20 offset:29824
    ds_read_b64_tr_b16 v[58:59], v20 offset:30592
    s_waitcnt lgkmcnt(8)
    v_mfma_f32_32x32x16_bf16 v[128:143], v[40:43], a[120:123], v[128:143]
    s_waitcnt vmcnt(2)
    s_barrier
    ds_read_b64_tr_b16 v[28:29], v26 offset:0
    ds_read_b64_tr_b16 v[30:31], v26 offset:256
    s_waitcnt lgkmcnt(8)
    v_mfma_f32_32x32x16_bf16 v[144:159], v[44:47], a[120:123], v[144:159]
    ds_read_b64_tr_b16 v[32:33], v26 offset:1024
    ds_read_b64_tr_b16 v[34:35], v26 offset:1280
    v_cmp_eq_u32 vcc, 1, v207
    s_nop 0
    s_cmp_eq_u64 vcc, -1
    s_cbranch_scc0 SP1
SP1_OK:
    s_atomic_add s53, s[36:37], s67
    s_waitcnt lgkmcnt(8)
    v_mfma_f32_32x32x16_bf16 v[112:127], v[48:51], a[124:127], v[112:127]
    ds_read_b64_tr_b16 v[36:37], v26 offset:2048
    ds_read_b64_tr_b16 v[38:39], v26 offset:2304
    s_waitcnt lgkmcnt(8)
    v_mfma_f32_32x32x16_bf16 v[128:143], v[52:55], a[124:127], v[128:143]
    ds_read_b64_tr_b16 v[40:41], v26 offset:3072
    ds_read_b64_tr_b16 v[42:43], v26 offset:3328
    s_waitcnt lgkmcnt(8)
    v_mfma_f32_32x32x16_bf16 v[144:159], v[56:59], a[124:127], v[144:159]
    ds_read_b64_tr_b16 v[44:45], v26 offset:4096
    ds_read_b64_tr_b16 v[46:47], v26 offset:4352
    s_waitcnt lgkmcnt(8)
    v_mfma_f32_32x32x16_bf16 v[96:111], v[28:31], a[0:3], 0
    ds_read_b64_tr_b16 v[48:49], v26 offset:5120
    ds_read_b64_tr_b16 v[50:51], v26 offset:5376
    s_waitcnt lgkmcnt(8)
    v_mfma_f32_32x32x16_bf16 v[96:111], v[32:35], a[4:7], v[96:111]
    ds_read_b64_tr_b16 v[52:53], v26 offset:6144
    ds_read_b64_tr_b16 v[54:55], v26 offset:6400
    s_waitcnt lgkmcnt(8)
    v_mfma_f32_32x32x16_bf16 v[96:111], v[36:39], a[8:11], v[96:111]
    ds_read_b64_tr_b16 v[56:57], v26 offset:7168
    ds_read_b64_tr_b16 v[58:59], v26 offset:7424
    s_waitcnt lgkmcnt(8)
    v_mfma_f32_32x32x16_bf16 v[96:111], v[40:43], a[12:15], v[96:111]
    ds_read_b64_tr_b16 v[28:29], v26 offset:8192
    ds_read_b64_tr_b16 v[30:31], v26 offset:8448
    s_waitcnt lgkmcnt(8)
    v_mfma_f32_32x32x16_bf16 v[96:111], v[44:47], a[16:19], v[96:111]
    ds_read_b64_tr_b16 v[32:33], v26 offset:9216
    ds_read_b64_tr_b16 v[34:35], v26 offset:9472
    s_waitcnt lgkmcnt(8)
    v_mfma_f32_32x32x16_bf16 v[96:111], v[48:51], a[20:23], v[96:111]
    ds_read_b64_tr_b16 v[36:37], v26 offset:10240
    ds_read_b64_tr_b16 v[38:39], v26 offset:10496
    s_waitcnt lgkmcnt(8)
    v_mfma_f32_32x32x16_bf16 v[96:111], v[52:55], a[24:27], v[96:111]
    ds_read_b64_tr_b16 v[40:41], v26 offset:11264
    ds_read_b64_tr_b16 v[42:43], v26 offset:11520
    s_waitcnt lgkmcnt(8)
    v_mfma_f32_32x32x16_bf16 v[96:111], v[56:59], a[28:31], v[96:111]
    ds_read_b64_tr_b16 v[44:45], v26 offset:12288
    ds_read_b64_tr_b16 v[46:47], v26 offset:12544
    s_waitcnt lgkmcnt(8)
    v_mfma_f32_32x32x16_bf16 v[96:111], v[28:31], a[32:35], v[96:111]
    ds_read_b64_tr_b16 v[48:49], v26 offset:13312
    ds_read_b64_tr_b16 v[50:51], v26 offset:13568
    s_waitcnt lgkmcnt(8)
    v_mfma_f32_32x32x16_bf16 v[96:111], v[32:35], a[36:39], v[96:111]
    ds_read_b64_tr_b16 v[52:53], v26 offset:14336
    ds_read_b64_tr_b16 v[54:55], v26 offset:14592
    s_waitcnt lgkmcnt(8)
    v_mfma_f32_32x32x16_bf16 v[96:111], v[36:39], a[40:43], v[96:111]
    ds_read_b64_tr_b16 v[56:57], v26 offset:15360
    ds_read_b64_tr_b16 v[58:59], v26 offset:15616
    s_waitcnt lgkmcnt(8)
    v_mfma_f32_32x32x16_bf16 v[96:111], v[40:43], a[44:47], v[96:111]
    ds_read_b64_tr_b16 v[28:29], v26 offset:16384
    ds_read_b64_tr_b16 v[30:31], v26 offset:16640
    s_waitcnt lgkmcnt(8)
    v_mfma_f32_32x32x16_bf16 v[96:111], v[44:47], a[48:51], v[96:111]
    ds_read_b64_tr_b16 v[32:33], v26 offset:17408
    ds_read_b64_tr_b16 v[34:35], v26 offset:17664
    s_waitcnt lgkmcnt(8)
    v_mfma_f32_32x32x16_bf16 v[96:111], v[48:51], a[52:55], v[96:111]
    ds_read_b64_tr_b16 v[36:37], v26 offset:18432
    ds_read_b64_tr_b16 v[38:39], v26 offset:18688
    s_waitcnt lgkmcnt(8)
    v_mfma_f32_32x32x16_bf16 v[96:111], v[52:55], a[56:59], v[96:111]
    ds_read_b64_tr_b16 v[40:41], v26 offset:19456
    ds_read_b64_tr_b16 v[42:43], v26 offset:19712
    s_add_u32 m0, s59, 0
    s_add_u32 s56, s83, 0
    buffer_load_dwordx4 v192, s[24:27], s56 offen offset:0 lds
    s_waitcnt lgkmcnt(8)
    v_mfma_f32_32x32x16_bf16 v[96:111], v[56:59], a[60:63], v[96:111]
    ds_read_b64_tr_b16 v[44:45], v26 offset:20480
    ds_read_b64_tr_b16 v[46:47], v26 offset:20736
    s_waitcnt lgkmcnt(8)
    v_mfma_f32_32x32x16_bf16 v[96:111], v[28:31], a[64:67], v[96:111]
    ds_read_b64_tr_b16 v[48:49], v26 offset:21504
    ds_read_b64_tr_b16 v[50:51], v26 offset:21760
    s_add_u32 m0, s59, 0
    s_nop 0
    buffer_load_dwordx4 v193, s[24:27], s56 offen offset:1024 lds
    s_waitcnt lgkmcnt(8)
    v_mfma_f32_32x32x16_bf16 v[96:111], v[32:35], a[68:71], v[96:111]
    ds_read_b64_tr_b16 v[52:53], v26 offset:22528
    ds_read_b64_tr_b16 v[54:55], v26 offset:22784
    s_waitcnt lgkmcnt(8)
    v_mfma_f32_32x32x16_bf16 v[96:111], v[36:39], a[72:75], v[96:111]
    ds_read_b64_tr_b16 v[56:57], v26 offset:23552
    ds_read_b64_tr_b16 v[58:59], v26 offset:23808
    s_add_u32 m0, s59, 0
    s_nop 0
    buffer_load_dwordx4 v194, s[24:27], s56 offen offset:2048 lds
    s_waitcnt lgkmcnt(8)
    v_mfma_f32_32x32x16_bf16 v[96:111], v[40:43], a[76:79], v[96:111]
    ds_read_b64_tr_b16 v[28:29], v26 offset:24576
    ds_read_b64_tr_b16 v[30:31], v26 offset:24832
    s_waitcnt lgkmcnt(8)
    v_mfma_f32_32x32x16_bf16 v[96:111], v[44:47], a[80:83], v[96:111]
    ds_read_b64_tr_b16 v[32:33], v26 offset:25600
    ds_read_b64_tr_b16 v[34:35], v26 offset:25856
    s_add_u32 m0, s59, 0
    s_nop 0
    buffer_load_dwordx4 v195, s[24:27], s56 offen offset:3072 lds
    s_waitcnt lgkmcnt(8)
    v_mfma_f32_32x32x16_bf16 v[96:111], v[48:51], a[84:87], v[96:111]
    ds_read_b64_tr_b16 v[36:37], v26 offset:26624
    ds_read_b64_tr_b16 v[38:39], v26 offset:26880
    s_waitcnt lgkmcnt(8)
    v_mfma_f32_32x32x16_bf16 v[96:111], v[52:55], a[88:91], v[96:111]
    ds_read_b64_tr_b16 v[40:41], v26 offset:27648
    ds_read_b64_tr_b16 v[42:43], v26 offset:27904
    s_waitcnt lgkmcnt(8)
    v_mfma_f32_32x32x16_bf16 v[96:111], v[56:59], a[92:95], v[96:111]
    ds_read_b64_tr_b16 v[44:45], v26 offset:28672
    ds_read_b64_tr_b16 v[46:47], v26 offset:28928
    s_add_u32 m0, s59, 16384
    s_add_u32 s56, s83, 32768
    buffer_load_dwordx4 v192, s[24:27], s56 offen offset:0 lds
    s_waitcnt lgkmcnt(8)
    v_mfma_f32_32x32x16_bf16 v[96:111], v[28:31], a[96:99], v[96:111]
    ds_read_b64_tr_b16 v[48:49], v26 offset:29696
    ds_read_b64_tr_b16 v[50:51], v26 offset:29952
    s_waitcnt lgkmcnt(8)
    v_mfma_f32_32x32x16_bf16 v[96:111], v[32:35], a[100:103], v[96:111]
    ds_read_b64_tr_b16 v[52:53], v26 offset:30720
    ds_read_b64_tr_b16 v[54:55], v26 offset:30976
    s_add_u32 m0, s59, 16384
    s_nop 0
    buffer_load_dwordx4 v193, s[24:27], s56 offen offset:1024 lds
    s_waitcnt lgkmcnt(8)
    v_mfma_f32_32x32x16_bf16 v[96:111], v[36:39], a[104:107], v[96:111]
    ds_read_b64_tr_b16 v[56:57], v26 offset:31744
    ds_read_b64_tr_b16 v[58:59], v26 offset:32000
    s_waitcnt lgkmcnt(8)
    v_mfma_f32_32x32x16_bf16 v[96:111], v[40:43], a[108:111], v[96:111]
    s_add_u32 m0, s59, 16384
    s_nop 0
    buffer_load_dwordx4 v194, s[24:27], s56 offen offset:2048 lds
    s_waitcnt lgkmcnt(6)
    v_mfma_f32_32x32x16_bf16 v[96:111], v[44:47], a[112:115], v[96:111]
    s_waitcnt lgkmcnt(4)
    v_mfma_f32_32x32x16_bf16 v[96:111], v[48:51], a[116:119], v[96:111]
    s_add_u32 m0, s59, 16384
    s_nop 0
    buffer_load_dwordx4 v195, s[24:27], s56 offen offset:3072 lds
    s_waitcnt lgkmcnt(2)
    v_mfma_f32_32x32x16_bf16 v[96:111], v[52:55], a[120:123], v[96:111]
    s_waitcnt lgkmcnt(0)
    v_mfma_f32_32x32x16_bf16 v[96:111], v[56:59], a[124:127], v[96:111]
    s_add_u32 s67, s48, 8192
    s_mov_b32 s0, 0xffff
    s_mov_b32 s1, 0xffff
    v_add_u32 v56, 65536, v196
    v_add_u32 v57, 65536, v197
    v_add_u32 v58, 131072, v196
    v_add_u32 v59, 131072, v197
    v_mov_b32 v52, 0x3fb8aa3b
    v_mov_b32 v53, 0x3fb8aa3b
    v_mov_b32 v54, 1.0
    v_mov_b32 v55, 1.0
    v_mov_b32 v2, -2.0
    v_mov_b32 v3, -2.0
    v_pk_mul_f32 v[160:161], v[112:113], v[52:53]
    v_pk_mul_f32 v[162:163], v[114:115], v[52:53]
    v_pk_mul_f32 v[164:165], v[116:117], v[52:53]
    v_pk_mul_f32 v[166:167], v[118:119], v[52:53]
    v_exp_f32_e64 v160, v160
    v_exp_f32 v161, v161
    v_exp_f32 v162, v162
    v_exp_f32 v163, v163
    v_exp_f32 v164, v164
    v_mul_f32 v96, 0x3eb8aa3b, v96
    v_mul_f32 v97, 0x3eb8aa3b, v97
    v_mul_f32 v98, 0x3eb8aa3b, v98
    v_mul_f32 v99, 0x3eb8aa3b, v99
    v_mul_f32 v100, 0x3eb8aa3b, v100
    v_mul_f32 v101, 0x3eb8aa3b, v101
    v_mul_f32 v102, 0x3eb8aa3b, v102
    v_mul_f32 v103, 0x3eb8aa3b, v103
    v_mul_f32 v104, 0x3eb8aa3b, v104
    v_mul_f32 v105, 0x3eb8aa3b, v105
    v_mul_f32 v106, 0x3eb8aa3b, v106
    v_mul_f32 v107, 0x3eb8aa3b, v107
    v_mul_f32 v108, 0x3eb8aa3b, v108
    v_mul_f32 v109, 0x3eb8aa3b, v109
    v_mul_f32 v110, 0x3eb8aa3b, v110
    v_mul_f32 v111, 0x3eb8aa3b, v111
    v_cvt_pk_bf16_f32 v64, v96, v97
    v_cvt_pk_bf16_f32 v65, v98, v99
    v_cvt_pk_bf16_f32 v66, v100, v101
    v_cvt_pk_bf16_f32 v67, v102, v103
    v_cvt_pk_bf16_f32 v68, v104, v105
    v_cvt_pk_bf16_f32 v69, v106, v107
    v_cvt_pk_bf16_f32 v70, v108, v109
    v_cvt_pk_bf16_f32 v71, v110, v111
    ds_write_b128 v21, v[64:67]
    ds_write_b128 v21, v[68:71] offset:4096
    v_exp_f32 v165, v165
    v_exp_f32 v166, v166
    v_exp_f32_e64 v167, v167
    v_pk_add_f32 v[160:161], v[160:161], v[54:55]
    v_pk_add_f32 v[162:163], v[162:163], v[54:55]
    v_pk_add_f32 v[164:165], v[164:165], v[54:55]
    v_pk_add_f32 v[166:167], v[166:167], v[54:55]
    v_pk_fma_f32 v[160:161], v[160:161], v[160:161], v[54:55]
    v_pk_fma_f32 v[162:163], v[162:163], v[162:163], v[54:55]
    v_pk_fma_f32 v[164:165], v[164:165], v[164:165], v[54:55]
    v_pk_fma_f32 v[166:167], v[166:167], v[166:167], v[54:55]
    s_add_u32 m0, s59, 32768
    s_add_u32 s56, s83, 65536
    buffer_load_dwordx4 v192, s[24:27], s56 offen offset:0 lds
    s_waitcnt lgkmcnt(0)
    s_barrier
    ds_read_b128 v[12:15], v22
    ds_read_b128 v[16:19], v22 offset:1024
    v_rcp_f32_e64 v160, v160
    v_rcp_f32 v161, v161
    v_rcp_f32 v162, v162
    v_rcp_f32 v163, v163
    v_rcp_f32 v164, v164
    v_rcp_f32 v165, v165
    v_rcp_f32 v166, v166
    s_add_u32 m0, s59, 32768
    s_nop 0
    buffer_load_dwordx4 v193, s[24:27], s56 offen offset:1024 lds
    v_rcp_f32 v167, v167
    v_pk_mul_f32 v[160:161], v[160:161], v[112:113]
    v_pk_mul_f32 v[162:163], v[162:163], v[114:115]
    v_pk_mul_f32 v[164:165], v[164:165], v[116:117]
    v_pk_mul_f32 v[166:167], v[166:167], v[118:119]
    v_pk_fma_f32 v[160:161], v[160:161], v[2:3], v[112:113]
    v_pk_fma_f32 v[162:163], v[162:163], v[2:3], v[114:115]
    v_pk_fma_f32 v[164:165], v[164:165], v[2:3], v[116:117]
    v_pk_fma_f32 v[166:167], v[166:167], v[2:3], v[118:119]
    v_cvt_pk_bf16_f32 v28, v160, v161
    v_cvt_pk_bf16_f32 v29, v162, v163
    v_cvt_pk_bf16_f32 v30, v164, v165
    v_cvt_pk_bf16_f32 v31, v166, v167
    s_add_u32 m0, s59, 32768
    s_nop 0
    buffer_load_dwordx4 v194, s[24:27], s56 offen offset:2048 lds
    s_mov_b32 s43, 0
    s_atomic_add s43, s[36:37], s68 glc
    s_mov_b32 s46, 0
    s_atomic_add s46, s[36:37], s51 glc
    s_mov_b32 s47, 0
    s_atomic_add s47, s[36:37], s52 glc
    v_pk_mul_f32 v[176:177], v[120:121], v[52:53]
    v_pk_mul_f32 v[178:179], v[122:123], v[52:53]
    v_pk_mul_f32 v[180:181], v[124:125], v[52:53]
    v_pk_mul_f32 v[182:183], v[126:127], v[52:53]
    v_exp_f32 v176, v176
    v_exp_f32 v177, v177
    v_exp_f32 v178, v178
    v_exp_f32 v179, v179
    v_exp_f32 v180, v180
    s_add_u32 m0, s59, 32768
    s_nop 0
    buffer_load_dwordx4 v195, s[24:27], s56 offen offset:3072 lds
    v_exp_f32 v181, v181
    v_exp_f32 v182, v182
    v_exp_f32_e64 v183, v183
    v_pk_add_f32 v[176:177], v[176:177], v[54:55]
    v_pk_add_f32 v[178:179], v[178:179], v[54:55]
    v_pk_add_f32 v[180:181], v[180:181], v[54:55]
    v_pk_add_f32 v[182:183], v[182:183], v[54:55]
    v_pk_fma_f32 v[176:177], v[176:177], v[176:177], v[54:55]
    v_pk_fma_f32 v[178:179], v[178:179], v[178:179], v[54:55]
    v_pk_fma_f32 v[180:181], v[180:181], v[180:181], v[54:55]
    v_pk_fma_f32 v[182:183], v[182:183], v[182:183], v[54:55]
    s_add_u32 m0, s59, 98304
    s_add_u32 s56, s83, 98304
    buffer_load_dwordx4 v192, s[24:27], s56 offen offset:0 lds
    v_rcp_f32_e64 v176, v176
    v_rcp_f32 v177, v177
    v_rcp_f32 v178, v178
    v_rcp_f32 v179, v179
    v_rcp_f32 v180, v180
    v_rcp_f32 v181, v181
    v_rcp_f32 v182, v182
    buffer_load_dwordx4 v193, s[24:27], s56 offen offset:1024 lds
    v_rcp_f32_e64 v183, v183
    v_pk_mul_f32 v[176:177], v[176:177], v[120:121]
    v_pk_mul_f32 v[178:179], v[178:179], v[122:123]
    v_pk_mul_f32 v[180:181], v[180:181], v[124:125]
    v_pk_mul_f32 v[182:183], v[182:183], v[126:127]
    v_pk_fma_f32 v[176:177], v[176:177], v[2:3], v[120:121]
    v_pk_fma_f32 v[178:179], v[178:179], v[2:3], v[122:123]
    v_pk_fma_f32 v[180:181], v[180:181], v[2:3], v[124:125]
    v_pk_fma_f32 v[182:183], v[182:183], v[2:3], v[126:127]
    v_cvt_pk_bf16_f32 v32, v176, v177
    v_cvt_pk_bf16_f32 v33, v178, v179
    v_cvt_pk_bf16_f32 v34, v180, v181
    v_cvt_pk_bf16_f32 v35, v182, v183
    buffer_load_dwordx4 v194, s[24:27], s56 offen offset:2048 lds
    v_pk_mul_f32 v[160:161], v[128:129], v[52:53]
    v_pk_mul_f32 v[162:163], v[130:131], v[52:53]
    v_pk_mul_f32 v[164:165], v[132:133], v[52:53]
    v_pk_mul_f32 v[166:167], v[134:135], v[52:53]
    v_exp_f32 v160, v160
    v_exp_f32 v161, v161
    v_exp_f32_e64 v162, v162
    v_exp_f32 v163, v163
    v_exp_f32 v164, v164
    buffer_load_dwordx4 v195, s[24:27], s56 offen offset:3072 lds
    v_exp_f32 v165, v165
    v_exp_f32 v166, v166
    v_exp_f32_e64 v167, v167
    v_pk_add_f32 v[160:161], v[160:161], v[54:55]
    v_pk_add_f32 v[162:163], v[162:163], v[54:55]
    v_pk_add_f32 v[164:165], v[164:165], v[54:55]
    v_pk_add_f32 v[166:167], v[166:167], v[54:55]
    v_pk_fma_f32 v[160:161], v[160:161], v[160:161], v[54:55]
    v_pk_fma_f32 v[162:163], v[162:163], v[162:163], v[54:55]
    v_pk_fma_f32 v[164:165], v[164:165], v[164:165], v[54:55]
    v_pk_fma_f32 v[166:167], v[166:167], v[166:167], v[54:55]
    s_add_u32 m0, s59, 114688
    s_add_u32 s56, s83, 131072
    buffer_load_dwordx4 v192, s[24:27], s56 offen offset:0 lds
    s_waitcnt lgkmcnt(0)
    s_and_b32 s43, s43, s46
    s_and_b32 s43, s43, s47
    s_cmp_eq_u32 s43, 8
    s_cbranch_scc0 SQ2
SQ2_OK:
    s_add_u32 s57, s69, 8192
    buffer_load_dwordx4 a[164:167], v60, s[36:39], s57 offen offset:1024 sc1
    buffer_load_dwordx4 a[160:163], v60, s[36:39], s57 offen offset:0 sc1
    v_rcp_f32 v160, v160
    v_rcp_f32_e64 v161, v161
    v_rcp_f32 v162, v162
    v_rcp_f32 v163, v163
    v_rcp_f32 v164, v164
    v_rcp_f32 v165, v165
    v_rcp_f32 v166, v166
    buffer_load_dwordx4 v193, s[24:27], s56 offen offset:1024 lds
    s_add_u32 s57, s69, 2105344
    s_mov_b64 exec, s[0:1]
    buffer_load_dwordx4 a[240:243], v61, s[36:39], s57 offen offset:1024 sc1
    buffer_load_dwordx4 a[244:247], v61, s[36:39], s57 offen offset:1536 sc1
    s_mov_b64 exec, -1
    s_mov_b64 exec, s[0:1]
    buffer_load_dwordx4 a[232:235], v61, s[36:39], s57 offen offset:0 sc1
    buffer_load_dwordx4 a[236:239], v61, s[36:39], s57 offen offset:512 sc1
    s_mov_b64 exec, -1
    v_rcp_f32 v167, v167
    v_pk_mul_f32 v[160:161], v[160:161], v[128:129]
    v_pk_mul_f32 v[162:163], v[162:163], v[130:131]
    v_pk_mul_f32 v[164:165], v[164:165], v[132:133]
    v_pk_mul_f32 v[166:167], v[166:167], v[134:135]
    v_pk_fma_f32 v[160:161], v[160:161], v[2:3], v[128:129]
    v_pk_fma_f32 v[162:163], v[162:163], v[2:3], v[130:131]
    v_pk_fma_f32 v[164:165], v[164:165], v[2:3], v[132:133]
    v_pk_fma_f32 v[166:167], v[166:167], v[2:3], v[134:135]
    v_cvt_pk_bf16_f32 v36, v160, v161
    v_cvt_pk_bf16_f32 v37, v162, v163
    v_cvt_pk_bf16_f32 v38, v164, v165
    v_cvt_pk_bf16_f32 v39, v166, v167
    buffer_load_dwordx4 v194, s[24:27], s56 offen offset:2048 lds
    s_add_u32 s57, s69, 6144
    s_cmp_ge_u32 s49, 1
    s_cselect_b32 s57, s57, 0x40000000
    buffer_load_dwordx4 a[156:159], v60, s[36:39], s57 offen offset:1024 sc1
    buffer_load_dwordx4 a[152:155], v60, s[36:39], s57 offen offset:0 sc1
    v_pk_mul_f32 v[176:177], v[136:137], v[52:53]
    v_pk_mul_f32 v[178:179], v[138:139], v[52:53]
    v_pk_mul_f32 v[180:181], v[140:141], v[52:53]
    v_pk_mul_f32 v[182:183], v[142:143], v[52:53]
    v_exp_f32 v176, v176
    v_exp_f32 v177, v177
    v_exp_f32 v178, v178
    v_exp_f32 v179, v179
    v_exp_f32_e64 v180, v180
    buffer_load_dwordx4 v195, s[24:27], s56 offen offset:3072 lds
    s_add_u32 s57, s69, 4096
    s_cmp_ge_u32 s49, 2
    s_cselect_b32 s57, s57, 0x40000000
    buffer_load_dwordx4 a[148:151], v60, s[36:39], s57 offen offset:1024 sc1
    buffer_load_dwordx4 a[144:147], v60, s[36:39], s57 offen offset:0 sc1
    v_exp_f32_e64 v181, v181
    v_exp_f32 v182, v182
    v_exp_f32 v183, v183
    v_pk_add_f32 v[176:177], v[176:177], v[54:55]
    v_pk_add_f32 v[178:179], v[178:179], v[54:55]
    v_pk_add_f32 v[180:181], v[180:181], v[54:55]
    v_pk_add_f32 v[182:183], v[182:183], v[54:55]
    v_pk_fma_f32 v[176:177], v[176:177], v[176:177], v[54:55]
    v_pk_fma_f32 v[178:179], v[178:179], v[178:179], v[54:55]
    v_pk_fma_f32 v[180:181], v[180:181], v[180:181], v[54:55]
    v_pk_fma_f32 v[182:183], v[182:183], v[182:183], v[54:55]
    s_add_u32 s57, s69, 2048
    s_cmp_ge_u32 s49, 3
    s_cselect_b32 s57, s57, 0x40000000
    buffer_load_dwordx4 a[140:143], v60, s[36:39], s57 offen offset:1024 sc1
    buffer_load_dwordx4 a[136:139], v60, s[36:39], s57 offen offset:0 sc1
    v_rcp_f32 v176, v176
    v_rcp_f32 v177, v177
    v_rcp_f32 v178, v178
    v_rcp_f32 v179, v179
    v_rcp_f32 v180, v180
    v_rcp_f32 v181, v181
    v_rcp_f32 v182, v182
    s_add_u32 s57, s69, 0
    s_cmp_ge_u32 s49, 4
    s_cselect_b32 s57, s57, 0x40000000
    buffer_load_dwordx4 a[132:135], v60, s[36:39], s57 offen offset:1024 sc1
    buffer_load_dwordx4 a[128:131], v60, s[36:39], s57 offen offset:0 sc1
    v_rcp_f32_e64 v183, v183
    v_pk_mul_f32 v[176:177], v[176:177], v[136:137]
    v_pk_mul_f32 v[178:179], v[178:179], v[138:139]
    v_pk_mul_f32 v[180:181], v[180:181], v[140:141]
    v_pk_mul_f32 v[182:183], v[182:183], v[142:143]
    v_pk_fma_f32 v[176:177], v[176:177], v[2:3], v[136:137]
    v_pk_fma_f32 v[178:179], v[178:179], v[2:3], v[138:139]
    v_pk_fma_f32 v[180:181], v[180:181], v[2:3], v[140:141]
    v_pk_fma_f32 v[182:183], v[182:183], v[2:3], v[142:143]
    v_cvt_pk_bf16_f32 v40, v176, v177
    v_cvt_pk_bf16_f32 v41, v178, v179
    v_cvt_pk_bf16_f32 v42, v180, v181
    v_cvt_pk_bf16_f32 v43, v182, v183
    v_pk_mul_f32 v[160:161], v[144:145], v[52:53]
    v_pk_mul_f32 v[162:163], v[146:147], v[52:53]
    v_pk_mul_f32 v[164:165], v[148:149], v[52:53]
    v_pk_mul_f32 v[166:167], v[150:151], v[52:53]
    v_exp_f32 v160, v160
    v_exp_f32 v161, v161
    v_exp_f32 v162, v162
    v_exp_f32 v163, v163
    v_exp_f32 v164, v164
    v_exp_f32 v165, v165
    v_exp_f32 v166, v166
    v_exp_f32 v167, v167
    v_pk_add_f32 v[160:161], v[160:161], v[54:55]
    v_pk_add_f32 v[162:163], v[162:163], v[54:55]
    v_pk_add_f32 v[164:165], v[164:165], v[54:55]
    v_pk_add_f32 v[166:167], v[166:167], v[54:55]
    v_pk_fma_f32 v[160:161], v[160:161], v[160:161], v[54:55]
    v_pk_fma_f32 v[162:163], v[162:163], v[162:163], v[54:55]
    v_pk_fma_f32 v[164:165], v[164:165], v[164:165], v[54:55]
    v_pk_fma_f32 v[166:167], v[166:167], v[166:167], v[54:55]
    v_rcp_f32 v160, v160
    v_rcp_f32 v161, v161
    v_rcp_f32 v162, v162
    v_rcp_f32 v163, v163
    v_rcp_f32 v164, v164
    v_rcp_f32 v165, v165
    v_rcp_f32 v166, v166
    v_rcp_f32 v167, v167
    v_pk_mul_f32 v[160:161], v[160:161], v[144:145]
    v_pk_mul_f32 v[162:163], v[162:163], v[146:147]
    v_pk_mul_f32 v[164:165], v[164:165], v[148:149]
    v_pk_mul_f32 v[166:167], v[166:167], v[150:151]
    v_pk_fma_f32 v[160:161], v[160:161], v[2:3], v[144:145]
    v_pk_fma_f32 v[162:163], v[162:163], v[2:3], v[146:147]
    v_pk_fma_f32 v[164:165], v[164:165], v[2:3], v[148:149]
    v_pk_fma_f32 v[166:167], v[166:167], v[2:3], v[150:151]
    v_cvt_pk_bf16_f32 v44, v160, v161
    v_cvt_pk_bf16_f32 v45, v162, v163
    v_cvt_pk_bf16_f32 v46, v164, v165
    v_cvt_pk_bf16_f32 v47, v166, v167
    v_pk_mul_f32 v[176:177], v[152:153], v[52:53]
    v_pk_mul_f32 v[178:179], v[154:155], v[52:53]
    v_pk_mul_f32 v[180:181], v[156:157], v[52:53]
    v_pk_mul_f32 v[182:183], v[158:159], v[52:53]
    v_exp_f32 v176, v176
    v_exp_f32 v177, v177
    v_exp_f32 v178, v178
    v_exp_f32 v179, v179
    v_exp_f32 v180, v180
    v_exp_f32 v181, v181
    v_exp_f32 v182, v182
    v_exp_f32 v183, v183
    v_pk_add_f32 v[176:177], v[176:177], v[54:55]
    v_pk_add_f32 v[178:179], v[178:179], v[54:55]
    v_pk_add_f32 v[180:181], v[180:181], v[54:55]
    v_pk_add_f32 v[182:183], v[182:183], v[54:55]
    v_pk_fma_f32 v[176:177], v[176:177], v[176:177], v[54:55]
    v_pk_fma_f32 v[178:179], v[178:179], v[178:179], v[54:55]
    v_pk_fma_f32 v[180:181], v[180:181], v[180:181], v[54:55]
    v_pk_fma_f32 v[182:183], v[182:183], v[182:183], v[54:55]
    v_rcp_f32 v176, v176
    v_rcp_f32 v177, v177
    v_rcp_f32 v178, v178
    v_rcp_f32 v179, v179
    v_rcp_f32 v180, v180
    v_rcp_f32 v181, v181
    v_rcp_f32 v182, v182
    v_rcp_f32 v183, v183
    v_pk_mul_f32 v[176:177], v[176:177], v[152:153]
    v_pk_mul_f32 v[178:179], v[178:179], v[154:155]
    v_pk_mul_f32 v[180:181], v[180:181], v[156:157]
    v_pk_mul_f32 v[182:183], v[182:183], v[158:159]
    v_pk_fma_f32 v[176:177], v[176:177], v[2:3], v[152:153]
    v_pk_fma_f32 v[178:179], v[178:179], v[2:3], v[154:155]
    v_pk_fma_f32 v[180:181], v[180:181], v[2:3], v[156:157]
    v_pk_fma_f32 v[182:183], v[182:183], v[2:3], v[158:159]
    v_cvt_pk_bf16_f32 v48, v176, v177
    v_cvt_pk_bf16_f32 v49, v178, v179
    v_cvt_pk_bf16_f32 v50, v180, v181
    v_cvt_pk_bf16_f32 v51, v182, v183
    buffer_store_dwordx4 v[28:31], v60, s[36:39], s72 offen offset:0 sc1
    buffer_store_dwordx4 v[32:35], v60, s[36:39], s72 offen offset:1024 sc1
    buffer_store_dwordx4 v[36:39], v60, s[36:39], s72 offen offset:2048 sc1
    buffer_store_dwordx4 v[40:43], v60, s[36:39], s72 offen offset:3072 sc1
    buffer_store_dwordx4 v[44:47], v60, s[36:39], s73 offen offset:0 sc1
    buffer_store_dwordx4 v[48:51], v60, s[36:39], s73 offen offset:1024 sc1
    s_mov_b32 exec_lo, 0
    s_mov_b32 exec_hi, 0x80000000
    buffer_store_dwordx2 v[24:25], v63, s[36:39], s71 offen sc1
    s_mov_b64 exec, -1
    v_mov_b32 v10, 0xf149f2ca
    v_mov_b32 v11, 0xf149f2ca
    s_waitcnt vmcnt(39)
    ds_read_b64_tr_b16 a[0:1], v196 offset:0
    ds_read_b64_tr_b16 a[2:3], v196 offset:1024
    ds_read_b64_tr_b16 a[4:5], v197 offset:0
    ds_read_b64_tr_b16 a[6:7], v197 offset:1024
    s_waitcnt vmcnt(37)
    ds_read_b64_tr_b16 a[8:9], v196 offset:2048
    ds_read_b64_tr_b16 a[10:11], v196 offset:3072
    ds_read_b64_tr_b16 a[12:13], v197 offset:2048
    ds_read_b64_tr_b16 a[14:15], v197 offset:3072
    s_waitcnt vmcnt(35)
    ds_read_b64_tr_b16 a[16:17], v196 offset:16384
    ds_read_b64_tr_b16 a[18:19], v196 offset:17408
    ds_read_b64_tr_b16 a[20:21], v197 offset:16384
    ds_read_b64_tr_b16 a[22:23], v197 offset:17408
    s_waitcnt vmcnt(33)
    ds_read_b64_tr_b16 a[24:25], v196 offset:18432
    ds_read_b64_tr_b16 a[26:27], v196 offset:19456
    ds_read_b64_tr_b16 a[28:29], v197 offset:18432
    ds_read_b64_tr_b16 a[30:31], v197 offset:19456
    s_waitcnt vmcnt(31)
    ds_read_b64_tr_b16 a[32:33], v196 offset:32768
    ds_read_b64_tr_b16 a[34:35], v196 offset:33792
    ds_read_b64_tr_b16 a[36:37], v197 offset:32768
    ds_read_b64_tr_b16 a[38:39], v197 offset:33792
    s_waitcnt vmcnt(29)
    ds_read_b64_tr_b16 a[40:41], v196 offset:34816
    ds_read_b64_tr_b16 a[42:43], v196 offset:35840
    ds_read_b64_tr_b16 a[44:45], v197 offset:34816
    ds_read_b64_tr_b16 a[46:47], v197 offset:35840
    s_waitcnt vmcnt(27)
    ds_read_b64_tr_b16 a[48:49], v56 offset:32768
    ds_read_b64_tr_b16 a[50:51], v56 offset:33792
    ds_read_b64_tr_b16 a[52:53], v57 offset:32768
    ds_read_b64_tr_b16 a[54:55], v57 offset:33792
    s_waitcnt vmcnt(25)
    ds_read_b64_tr_b16 a[56:57], v56 offset:34816
    ds_read_b64_tr_b16 a[58:59], v56 offset:35840
    ds_read_b64_tr_b16 a[60:61], v57 offset:34816
    ds_read_b64_tr_b16 a[62:63], v57 offset:35840
    s_waitcnt vmcnt(21)
    ds_read_b64_tr_b16 a[64:65], v56 offset:49152
    ds_read_b64_tr_b16 a[66:67], v56 offset:50176
    ds_read_b64_tr_b16 a[68:69], v57 offset:49152
    ds_read_b64_tr_b16 a[70:71], v57 offset:50176
    s_waitcnt vmcnt(13)
    ds_read_b64_tr_b16 a[72:73], v56 offset:51200
    ds_read_b64_tr_b16 a[74:75], v56 offset:52224
    ds_read_b64_tr_b16 a[76:77], v57 offset:51200
    ds_read_b64_tr_b16 a[78:79], v57 offset:52224
    v_mfma_f32_32x32x16_bf16 v[80:95], a[164:167], v[16:19], v[224:239]
    v_mfma_f32_32x32x16_bf16 v[96:111], a[160:163], v[16:19], v[208:223]
    s_nop 10
    v_exp_f32 v80, v80
    v_exp_f32 v81, v81
    v_exp_f32 v82, v82
    v_exp_f32 v83, v83
    s_add_u32 s57, s69, 2103296
    s_cmp_ge_u32 s49, 1
    s_cselect_b32 s57, s57, 0x40000000
    s_mov_b64 exec, s[0:1]
    buffer_load_dwordx4 a[224:227], v61, s[36:39], s57 offen offset:1024 sc1
    buffer_load_dwordx4 a[228:231], v61, s[36:39], s57 offen offset:1536 sc1
    s_mov_b64 exec, -1
    v_exp_f32 v84, v84
    v_exp_f32_e64 v85, v85
    v_mfma_f32_32x32x16_bf16 v[64:79], a[160:163], v[12:15], v[224:239]
    v_exp_f32 v86, v86
    v_exp_f32 v87, v87
    v_cvt_pk_bf16_f32 v2, v80, v81
    v_cvt_pk_bf16_f32 v3, v82, v83
    v_cvt_pk_bf16_f32 v4, v84, v85
    v_cvt_pk_bf16_f32 v5, v86, v87
    s_mov_b64 exec, s[0:1]
    buffer_load_dwordx4 a[216:219], v61, s[36:39], s57 offen offset:0 sc1
    buffer_load_dwordx4 a[220:223], v61, s[36:39], s57 offen offset:512 sc1
    s_mov_b64 exec, -1
    v_exp_f32 v88, v88
    v_exp_f32 v89, v89
    v_mfma_f32_32x32x16_bf16 v[160:175], a[240:243], v[2:5], 0
    v_exp_f32 v90, v90
    v_exp_f32 v91, v91
    v_exp_f32_e64 v92, v92
    v_exp_f32 v93, v93
    s_add_u32 s57, s69, 2101248
    s_cmp_ge_u32 s49, 2
    s_cselect_b32 s57, s57, 0x40000000
    s_mov_b64 exec, s[0:1]
    buffer_load_dwordx4 a[208:211], v61, s[36:39], s57 offen offset:1024 sc1
    buffer_load_dwordx4 a[212:215], v61, s[36:39], s57 offen offset:1536 sc1
    s_mov_b64 exec, -1
    v_exp_f32 v94, v94
    v_exp_f32_e64 v95, v95
    v_cvt_pk_bf16_f32 v6, v88, v89
    v_cvt_pk_bf16_f32 v7, v90, v91
    v_cvt_pk_bf16_f32 v8, v92, v93
    v_cvt_pk_bf16_f32 v9, v94, v95
    v_exp_f32 v96, v96
    v_exp_f32 v97, v97
    v_mfma_f32_32x32x16_bf16 v[160:175], a[244:247], v[6:9], v[160:175]
    v_exp_f32_e64 v98, v98
    v_exp_f32 v99, v99
    s_mov_b64 exec, s[0:1]
    buffer_load_dwordx4 a[200:203], v61, s[36:39], s57 offen offset:0 sc1
    buffer_load_dwordx4 a[204:207], v61, s[36:39], s57 offen offset:512 sc1
    s_mov_b64 exec, -1
    v_exp_f32 v100, v100
    v_exp_f32_e64 v101, v101
    s_cmp_eq_u32 s49, 0
    s_cbranch_scc1 SW3
SW3_R:
    v_mfma_f32_32x32x16_bf16 v[80:95], a[156:159], v[16:19], v[208:223]
    v_exp_f32 v102, v102
    v_exp_f32 v103, v103
    v_cvt_pk_bf16_f32 v2, v96, v97
    v_cvt_pk_bf16_f32 v3, v98, v99
    v_cvt_pk_bf16_f32 v4, v100, v101
    v_cvt_pk_bf16_f32 v5, v102, v103
    s_add_u32 s57, s69, 2099200
    s_cmp_ge_u32 s49, 3
    s_cselect_b32 s57, s57, 0x40000000
    s_mov_b64 exec, s[0:1]
    buffer_load_dwordx4 a[192:195], v61, s[36:39], s57 offen offset:1024 sc1
    buffer_load_dwordx4 a[196:199], v61, s[36:39], s57 offen offset:1536 sc1
    s_mov_b64 exec, -1
    v_exp_f32 v104, v104
    v_exp_f32 v105, v105
    v_mfma_f32_32x32x16_bf16 v[160:175], a[232:235], v[2:5], v[160:175]
    v_exp_f32 v106, v106
    v_exp_f32 v107, v107
    v_exp_f32_e64 v108, v108
    v_exp_f32 v109, v109
    s_mov_b64 exec, s[0:1]
    buffer_load_dwordx4 a[184:187], v61, s[36:39], s57 offen offset:0 sc1
    buffer_load_dwordx4 a[188:191], v61, s[36:39], s57 offen offset:512 sc1
    s_mov_b64 exec, -1
    v_exp_f32 v110, v110
    v_exp_f32_e64 v111, v111
    v_cvt_pk_bf16_f32 v6, v104, v105
    v_cvt_pk_bf16_f32 v7, v106, v107
    v_cvt_pk_bf16_f32 v8, v108, v109
    v_cvt_pk_bf16_f32 v9, v110, v111
    v_exp_f32 v64, v64
    v_exp_f32 v65, v65
    v_mfma_f32_32x32x16_bf16 v[160:175], a[236:239], v[6:9], v[160:175]
    v_exp_f32_e64 v66, v66
    v_exp_f32 v67, v67
    s_add_u32 s57, s69, 2097152
    s_cmp_ge_u32 s49, 4
    s_cselect_b32 s57, s57, 0x40000000
    s_mov_b64 exec, s[0:1]
    buffer_load_dwordx4 a[176:179], v61, s[36:39], s57 offen offset:1024 sc1
    buffer_load_dwordx4 a[180:183], v61, s[36:39], s57 offen offset:1536 sc1
    s_mov_b64 exec, -1
    v_exp_f32 v68, v68
    v_exp_f32_e64 v69, v69
    v_mfma_f32_32x32x16_bf16 v[96:111], a[156:159], v[12:15], v[208:223]
    v_exp_f32 v70, v70
    v_exp_f32 v71, v71
    v_cvt_pk_bf16_f32 v2, v64, v65
    v_cvt_pk_bf16_f32 v3, v66, v67
    v_cvt_pk_bf16_f32 v4, v68, v69
    v_cvt_pk_bf16_f32 v5, v70, v71
    s_mov_b64 exec, s[0:1]
    buffer_load_dwordx4 a[168:171], v61, s[36:39], s57 offen offset:0 sc1
    buffer_load_dwordx4 a[172:175], v61, s[36:39], s57 offen offset:512 sc1
    s_mov_b64 exec, -1
    v_exp_f32 v72, v72
    v_exp_f32 v73, v73
    v_mfma_f32_32x32x16_bf16 v[144:159], a[232:235], v[2:5], 0
    v_exp_f32 v74, v74
    v_exp_f32 v75, v75
    v_exp_f32 v76, v76
    v_exp_f32 v77, v77
    v_exp_f32 v78, v78
    v_exp_f32 v79, v79
    v_cvt_pk_bf16_f32 v6, v72, v73
    v_cvt_pk_bf16_f32 v7, v74, v75
    v_cvt_pk_bf16_f32 v8, v76, v77
    v_cvt_pk_bf16_f32 v9, v78, v79
    v_exp_f32 v80, v80
    v_exp_f32 v81, v81
    v_mfma_f32_32x32x16_bf16 v[144:159], a[236:239], v[6:9], v[144:159]
    v_exp_f32 v82, v82
    v_exp_f32 v83, v83
    s_add_u32 m0, s59, 131072
    s_add_u32 s56, s83, 163840
    buffer_load_dwordx4 v192, s[24:27], s56 offen offset:0 lds
    v_exp_f32 v84, v84
    v_exp_f32 v85, v85
    v_mfma_f32_32x32x16_bf16 v[64:79], a[152:155], v[16:19], v[208:223]
    v_exp_f32 v86, v86
    v_exp_f32 v87, v87
    v_cvt_pk_bf16_f32 v2, v80, v81
    v_cvt_pk_bf16_f32 v3, v82, v83
    v_cvt_pk_bf16_f32 v4, v84, v85
    v_cvt_pk_bf16_f32 v5, v86, v87
    s_waitcnt vmcnt(17)
    s_atomic_add s53, s[36:37], s74
    buffer_load_dwordx4 v193, s[24:27], s56 offen offset:1024 lds
    v_exp_f32 v88, v88
    v_exp_f32 v89, v89
    s_waitcnt vmcnt(16)
    v_mfma_f32_32x32x16_bf16 v[160:175], a[224:227], v[2:5], v[160:175]
    v_exp_f32 v90, v90
    v_exp_f32 v91, v91
    v_exp_f32 v92, v92
    v_exp_f32 v93, v93
    buffer_load_dwordx4 v194, s[24:27], s56 offen offset:2048 lds
    v_exp_f32 v94, v94
    v_exp_f32 v95, v95
    v_cvt_pk_bf16_f32 v6, v88, v89
    v_cvt_pk_bf16_f32 v7, v90, v91
    v_cvt_pk_bf16_f32 v8, v92, v93
    v_cvt_pk_bf16_f32 v9, v94, v95
    v_exp_f32 v96, v96
    v_exp_f32 v97, v97
    v_mfma_f32_32x32x16_bf16 v[160:175], a[228:231], v[6:9], v[160:175]
    v_exp_f32 v98, v98
    v_exp_f32 v99, v99
    buffer_load_dwordx4 v195, s[24:27], s56 offen offset:3072 lds
    v_exp_f32 v100, v100
    v_exp_f32 v101, v101
    v_mfma_f32_32x32x16_bf16 v[80:95], a[152:155], v[12:15], v[208:223]
    v_exp_f32 v102, v102
    v_exp_f32 v103, v103
    v_cvt_pk_bf16_f32 v2, v96, v97
    v_cvt_pk_bf16_f32 v3, v98, v99
    v_cvt_pk_bf16_f32 v4, v100, v101
    v_cvt_pk_bf16_f32 v5, v102, v103
    s_add_u32 m0, s59, 147456
    s_add_u32 s56, s83, 196608
    buffer_load_dwordx4 v192, s[24:27], s56 offen offset:0 lds
    v_exp_f32 v104, v104
    v_exp_f32 v105, v105
    v_mfma_f32_32x32x16_bf16 v[144:159], a[224:227], v[2:5], v[144:159]
    v_exp_f32 v106, v106
    v_exp_f32 v107, v107
    v_exp_f32 v108, v108
    v_exp_f32 v109, v109
    buffer_load_dwordx4 v193, s[24:27], s56 offen offset:1024 lds
    v_exp_f32 v110, v110
    v_exp_f32 v111, v111
    v_cvt_pk_bf16_f32 v6, v104, v105
    v_cvt_pk_bf16_f32 v7, v106, v107
    v_cvt_pk_bf16_f32 v8, v108, v109
    v_cvt_pk_bf16_f32 v9, v110, v111
    v_exp_f32 v64, v64
    v_exp_f32 v65, v65
    v_mfma_f32_32x32x16_bf16 v[144:159], a[228:231], v[6:9], v[144:159]
    v_exp_f32 v66, v66
    v_exp_f32 v67, v67
    buffer_load_dwordx4 v194, s[24:27], s56 offen offset:2048 lds
    v_exp_f32 v68, v68
    v_exp_f32 v69, v69
    s_cmp_eq_u32 s49, 1
    s_cbranch_scc1 SW4
SW4_R:
    v_mfma_f32_32x32x16_bf16 v[96:111], a[148:151], v[16:19], v[208:223]
    v_exp_f32 v70, v70
    v_exp_f32 v71, v71
    v_cvt_pk_bf16_f32 v2, v64, v65
    v_cvt_pk_bf16_f32 v3, v66, v67
    v_cvt_pk_bf16_f32 v4, v68, v69
    v_cvt_pk_bf16_f32 v5, v70, v71
    buffer_load_dwordx4 v195, s[24:27], s56 offen offset:3072 lds
    v_exp_f32_e64 v72, v72
    v_exp_f32 v73, v73
    s_waitcnt vmcnt(20)
    v_mfma_f32_32x32x16_bf16 v[160:175], a[216:219], v[2:5], v[160:175]
    v_exp_f32 v74, v74
    v_exp_f32 v75, v75
    v_exp_f32 v76, v76
    v_exp_f32 v77, v77
    s_add_u32 m0, s59, 49152
    s_add_u32 s56, s83, 229376
    buffer_load_dwordx4 v192, s[24:27], s56 offen offset:0 lds
    v_exp_f32 v78, v78
    v_exp_f32 v79, v79
    v_cvt_pk_bf16_f32 v6, v72, v73
    v_cvt_pk_bf16_f32 v7, v74, v75
    v_cvt_pk_bf16_f32 v8, v76, v77
    v_cvt_pk_bf16_f32 v9, v78, v79
    v_exp_f32 v80, v80
    v_exp_f32 v81, v81
    v_mfma_f32_32x32x16_bf16 v[160:175], a[220:223], v[6:9], v[160:175]
    v_exp_f32 v82, v82
    v_exp_f32 v83, v83
    buffer_load_dwordx4 v193, s[24:27], s56 offen offset:1024 lds
    v_exp_f32 v84, v84
    v_exp_f32 v85, v85
    v_mfma_f32_32x32x16_bf16 v[64:79], a[148:151], v[12:15], v[208:223]
    v_exp_f32 v86, v86
    v_exp_f32 v87, v87
    v_cvt_pk_bf16_f32 v2, v80, v81
    v_cvt_pk_bf16_f32 v3, v82, v83
    v_cvt_pk_bf16_f32 v4, v84, v85
    v_cvt_pk_bf16_f32 v5, v86, v87
    buffer_load_dwordx4 v194, s[24:27], s56 offen offset:2048 lds
    v_exp_f32 v88, v88
    v_exp_f32 v89, v89
    v_mfma_f32_32x32x16_bf16 v[144:159], a[216:219], v[2:5], v[144:159]
    v_exp_f32 v90, v90
    v_exp_f32 v91, v91
    v_exp_f32 v92, v92
    v_exp_f32 v93, v93
    buffer_load_dwordx4 v195, s[24:27], s56 offen offset:3072 lds
    v_exp_f32 v94, v94
    v_exp_f32 v95, v95
    v_cvt_pk_bf16_f32 v6, v88, v89
    v_cvt_pk_bf16_f32 v7, v90, v91
    v_cvt_pk_bf16_f32 v8, v92, v93
    v_cvt_pk_bf16_f32 v9, v94, v95
    v_exp_f32 v96, v96
    v_exp_f32 v97, v97
    v_mfma_f32_32x32x16_bf16 v[144:159], a[220:223], v[6:9], v[144:159]
    v_exp_f32 v98, v98
    v_exp_f32 v99, v99
    s_add_u32 m0, s59, 65536
    s_add_u32 s56, s83, 262144
    buffer_load_dwordx4 v192, s[24:27], s56 offen offset:0 lds
    v_exp_f32 v100, v100
    v_exp_f32 v101, v101
    v_mfma_f32_32x32x16_bf16 v[80:95], a[144:147], v[16:19], v[208:223]
    v_exp_f32 v102, v102
    v_exp_f32 v103, v103
    v_cvt_pk_bf16_f32 v2, v96, v97
    v_cvt_pk_bf16_f32 v3, v98, v99
    v_cvt_pk_bf16_f32 v4, v100, v101
    v_cvt_pk_bf16_f32 v5, v102, v103
    buffer_load_dwordx4 v193, s[24:27], s56 offen offset:1024 lds
    v_exp_f32_e64 v104, v104
    v_exp_f32 v105, v105
    s_waitcnt vmcnt(24)
    v_mfma_f32_32x32x16_bf16 v[160:175], a[208:211], v[2:5], v[160:175]
    v_exp_f32 v106, v106
    v_exp_f32 v107, v107
    v_exp_f32 v108, v108
    v_exp_f32 v109, v109
    buffer_load_dwordx4 v194, s[24:27], s56 offen offset:2048 lds
    v_exp_f32 v110, v110
    v_exp_f32 v111, v111
    v_cvt_pk_bf16_f32 v6, v104, v105
    v_cvt_pk_bf16_f32 v7, v106, v107
    v_cvt_pk_bf16_f32 v8, v108, v109
    v_cvt_pk_bf16_f32 v9, v110, v111
    v_exp_f32 v64, v64
    v_exp_f32 v65, v65
    v_mfma_f32_32x32x16_bf16 v[160:175], a[212:215], v[6:9], v[160:175]
    v_exp_f32 v66, v66
    v_exp_f32 v67, v67
    buffer_load_dwordx4 v195, s[24:27], s56 offen offset:3072 lds
    v_exp_f32 v68, v68
    v_exp_f32 v69, v69
    v_mfma_f32_32x32x16_bf16 v[96:111], a[144:147], v[12:15], v[208:223]
    v_exp_f32 v70, v70
    v_exp_f32 v71, v71
    v_cvt_pk_bf16_f32 v2, v64, v65
    v_cvt_pk_bf16_f32 v3, v66, v67
    v_cvt_pk_bf16_f32 v4, v68, v69
    v_cvt_pk_bf16_f32 v5, v70, v71
    s_add_u32 m0, s59, 81920
    s_add_u32 s56, s83, 294912
    buffer_load_dwordx4 v192, s[24:27], s56 offen offset:0 lds
    v_exp_f32 v72, v72
    v_exp_f32 v73, v73
    v_mfma_f32_32x32x16_bf16 v[144:159], a[208:211], v[2:5], v[144:159]
    v_exp_f32 v74, v74
    v_exp_f32 v75, v75
    v_exp_f32 v76, v76
    v_exp_f32 v77, v77
    buffer_load_dwordx4 v193, s[24:27], s56 offen offset:1024 lds
    v_exp_f32 v78, v78
    v_exp_f32 v79, v79
    v_cvt_pk_bf16_f32 v6, v72, v73
    v_cvt_pk_bf16_f32 v7, v74, v75
    v_cvt_pk_bf16_f32 v8, v76, v77
    v_cvt_pk_bf16_f32 v9, v78, v79
    v_exp_f32 v80, v80
    v_exp_f32 v81, v81
    v_mfma_f32_32x32x16_bf16 v[144:159], a[212:215], v[6:9], v[144:159]
    v_exp_f32 v82, v82
    v_exp_f32 v83, v83
    buffer_load_dwordx4 v194, s[24:27], s56 offen offset:2048 lds
    v_exp_f32 v84, v84
    v_exp_f32 v85, v85
    s_cmp_eq_u32 s49, 2
    s_cbranch_scc1 SW5
SW5_R:
    v_mfma_f32_32x32x16_bf16 v[64:79], a[140:143], v[16:19], v[208:223]
    v_exp_f32 v86, v86
    v_exp_f32 v87, v87
    v_cvt_pk_bf16_f32 v2, v80, v81
    v_cvt_pk_bf16_f32 v3, v82, v83
    v_cvt_pk_bf16_f32 v4, v84, v85
    v_cvt_pk_bf16_f32 v5, v86, v87
    buffer_load_dwordx4 v195, s[24:27], s56 offen offset:3072 lds
    v_exp_f32_e64 v88, v88
    v_exp_f32 v89, v89
    s_waitcnt vmcnt(28)
    v_mfma_f32_32x32x16_bf16 v[160:175], a[200:203], v[2:5], v[160:175]
    v_exp_f32 v90, v90
    v_exp_f32 v91, v91
    v_exp_f32 v92, v92
    v_exp_f32 v93, v93
    s_waitcnt lgkmcnt(15)
    s_add_u32 m0, s59, 0
    s_add_u32 s56, s83, 327680
    buffer_load_dwordx4 v192, s[24:27], s56 offen offset:0 lds
    v_exp_f32 v94, v94
    v_exp_f32 v95, v95
    v_cvt_pk_bf16_f32 v6, v88, v89
    v_cvt_pk_bf16_f32 v7, v90, v91
    v_cvt_pk_bf16_f32 v8, v92, v93
    v_cvt_pk_bf16_f32 v9, v94, v95
    v_exp_f32 v96, v96
    v_exp_f32 v97, v97
    v_mfma_f32_32x32x16_bf16 v[160:175], a[204:207], v[6:9], v[160:175]
    v_exp_f32 v98, v98
    v_exp_f32 v99, v99
    buffer_load_dwordx4 v193, s[24:27], s56 offen offset:1024 lds
    v_exp_f32 v100, v100
    v_exp_f32 v101, v101
    v_mfma_f32_32x32x16_bf16 v[80:95], a[140:143], v[12:15], v[208:223]
    v_exp_f32 v102, v102
    v_exp_f32 v103, v103
    v_cvt_pk_bf16_f32 v2, v96, v97
    v_cvt_pk_bf16_f32 v3, v98, v99
    v_cvt_pk_bf16_f32 v4, v100, v101
    v_cvt_pk_bf16_f32 v5, v102, v103
    s_cmp_ge_u32 s3, 2
    s_cselect_b32 s56, 0x40000000, s56
    buffer_load_dwordx4 v194, s[24:27], s56 offen offset:2048 lds
    v_exp_f32 v104, v104
    v_exp_f32 v105, v105
    v_mfma_f32_32x32x16_bf16 v[144:159], a[200:203], v[2:5], v[144:159]
    v_exp_f32 v106, v106
    v_exp_f32 v107, v107
    v_exp_f32 v108, v108
    v_exp_f32 v109, v109
    buffer_load_dwordx4 v195, s[24:27], s56 offen offset:3072 lds
    v_exp_f32 v110, v110
    v_exp_f32 v111, v111
    v_cvt_pk_bf16_f32 v6, v104, v105
    v_cvt_pk_bf16_f32 v7, v106, v107
    v_cvt_pk_bf16_f32 v8, v108, v109
    v_cvt_pk_bf16_f32 v9, v110, v111
    v_exp_f32 v64, v64
    v_exp_f32 v65, v65
    v_mfma_f32_32x32x16_bf16 v[144:159], a[204:207], v[6:9], v[144:159]
    v_exp_f32 v66, v66
    v_exp_f32 v67, v67
    s_waitcnt lgkmcnt(15)
    s_add_u32 m0, s59, 16384
    s_add_u32 s56, s84, 0
    buffer_load_dwordx4 v192, s[12:15], s56 offen offset:0 lds
    v_exp_f32 v68, v68
    v_exp_f32 v69, v69
    v_mfma_f32_32x32x16_bf16 v[96:111], a[136:139], v[16:19], v[208:223]
    v_exp_f32 v70, v70
    v_exp_f32 v71, v71
    v_cvt_pk_bf16_f32 v2, v64, v65
    v_cvt_pk_bf16_f32 v3, v66, v67
    v_cvt_pk_bf16_f32 v4, v68, v69
    v_cvt_pk_bf16_f32 v5, v70, v71
    buffer_load_dwordx4 v193, s[12:15], s56 offen offset:1024 lds
    s_mov_b32 s43, 0
    s_atomic_add s43, s[36:37], s75 glc
    v_exp_f32 v72, v72
    v_exp_f32 v73, v73
    s_waitcnt vmcnt(32)
    v_mfma_f32_32x32x16_bf16 v[160:175], a[192:195], v[2:5], v[160:175]
    v_exp_f32 v74, v74
    v_exp_f32 v75, v75
    v_exp_f32 v76, v76
    v_exp_f32 v77, v77
    buffer_load_dwordx4 v194, s[12:15], s56 offen offset:2048 lds
    v_exp_f32 v78, v78
    v_exp_f32 v79, v79
    v_cvt_pk_bf16_f32 v6, v72, v73
    v_cvt_pk_bf16_f32 v7, v74, v75
    v_cvt_pk_bf16_f32 v8, v76, v77
    v_cvt_pk_bf16_f32 v9, v78, v79
    v_exp_f32 v80, v80
    v_exp_f32 v81, v81
    v_mfma_f32_32x32x16_bf16 v[160:175], a[196:199], v[6:9], v[160:175]
    v_exp_f32 v82, v82
    v_exp_f32 v83, v83
    buffer_load_dwordx4 v195, s[12:15], s56 offen offset:3072 lds
    v_exp_f32 v84, v84
    v_exp_f32 v85, v85
    v_mfma_f32_32x32x16_bf16 v[64:79], a[136:139], v[12:15], v[208:223]
    v_exp_f32 v86, v86
    v_exp_f32 v87, v87
    v_cvt_pk_bf16_f32 v2, v80, v81
    v_cvt_pk_bf16_f32 v3, v82, v83
    v_cvt_pk_bf16_f32 v4, v84, v85
    v_cvt_pk_bf16_f32 v5, v86, v87
    s_waitcnt lgkmcnt(15)
    s_add_u32 m0, s59, 32768
    s_add_u32 s56, s84, 32768
    buffer_load_dwordx4 v192, s[12:15], s56 offen offset:0 lds
    v_exp_f32 v88, v88
    v_exp_f32_e64 v89, v89
    v_mfma_f32_32x32x16_bf16 v[144:159], a[192:195], v[2:5], v[144:159]
    v_exp_f32 v90, v90
    v_exp_f32 v91, v91
    v_exp_f32 v92, v92
    v_exp_f32 v93, v93
    buffer_load_dwordx4 v193, s[12:15], s56 offen offset:1024 lds
    v_exp_f32 v94, v94
    v_exp_f32 v95, v95
    v_cvt_pk_bf16_f32 v6, v88, v89
    v_cvt_pk_bf16_f32 v7, v90, v91
    v_cvt_pk_bf16_f32 v8, v92, v93
    v_cvt_pk_bf16_f32 v9, v94, v95
    v_exp_f32 v96, v96
    v_exp_f32 v97, v97
    v_mfma_f32_32x32x16_bf16 v[144:159], a[196:199], v[6:9], v[144:159]
    v_exp_f32 v98, v98
    v_exp_f32 v99, v99
    buffer_load_dwordx4 v194, s[12:15], s56 offen offset:2048 lds
    v_exp_f32 v100, v100
    v_exp_f32 v101, v101
    s_cmp_eq_u32 s49, 3
    s_cbranch_scc1 SW6
SW6_R:
    v_mfma_f32_32x32x16_bf16 v[80:95], a[132:135], v[16:19], v[240:255]
    v_exp_f32 v102, v102
    v_exp_f32 v103, v103
    v_cvt_pk_bf16_f32 v2, v96, v97
    v_cvt_pk_bf16_f32 v3, v98, v99
    v_cvt_pk_bf16_f32 v4, v100, v101
    v_cvt_pk_bf16_f32 v5, v102, v103
    buffer_load_dwordx4 v195, s[12:15], s56 offen offset:3072 lds
    v_exp_f32_e64 v104, v104
    v_exp_f32 v105, v105
    s_waitcnt vmcnt(36)
    v_mfma_f32_32x32x16_bf16 v[160:175], a[184:187], v[2:5], v[160:175]
    v_exp_f32_e64 v106, v106
    v_exp_f32 v107, v107
    v_exp_f32 v108, v108
    v_exp_f32 v109, v109
    s_waitcnt lgkmcnt(8)
    s_add_u32 m0, s59, 98304
    s_add_u32 s56, s84, 65536
    buffer_load_dwordx4 v192, s[12:15], s56 offen offset:0 lds
    s_waitcnt lgkmcnt(0)
    s_cmp_eq_u32 s43, 32
    s_cbranch_scc0 SQ7
SQ7_OK:
    s_add_u32 s55, s76, 0
    buffer_load_dwordx4 a[80:83], v198, s[36:39], s55 offen offset:0 sc1
    buffer_load_dwordx4 a[84:87], v199, s[36:39], s55 offen offset:0 sc1
    v_exp_f32 v110, v110
    v_exp_f32 v111, v111
    v_cvt_pk_bf16_f32 v6, v104, v105
    v_cvt_pk_bf16_f32 v7, v106, v107
    v_cvt_pk_bf16_f32 v8, v108, v109
    v_cvt_pk_bf16_f32 v9, v110, v111
    v_exp_f32 v64, v64
    v_exp_f32 v65, v65
    v_mfma_f32_32x32x16_bf16 v[160:175], a[188:191], v[6:9], v[160:175]
    v_exp_f32 v66, v66
    v_exp_f32 v67, v67
    buffer_load_dwordx4 v193, s[12:15], s56 offen offset:1024 lds
    v_exp_f32 v68, v68
    v_exp_f32 v69, v69
    v_mfma_f32_32x32x16_bf16 v[96:111], a[132:135], v[12:15], v[208:223]
    v_exp_f32 v70, v70
    v_exp_f32 v71, v71
    v_cvt_pk_bf16_f32 v2, v64, v65
    v_cvt_pk_bf16_f32 v3, v66, v67
    v_cvt_pk_bf16_f32 v4, v68, v69
    v_cvt_pk_bf16_f32 v5, v70, v71
    buffer_load_dwordx4 v194, s[12:15], s56 offen offset:2048 lds
    buffer_load_dwordx4 a[88:91], v198, s[36:39], s55 offen offset:1024 sc1
    buffer_load_dwordx4 a[92:95], v199, s[36:39], s55 offen offset:1024 sc1
    v_exp_f32 v72, v72
    v_exp_f32 v73, v73
    v_mfma_f32_32x32x16_bf16 v[144:159], a[184:187], v[2:5], v[144:159]
    v_exp_f32 v74, v74
    v_exp_f32 v75, v75
    v_exp_f32 v76, v76
    v_exp_f32 v77, v77
    buffer_load_dwordx4 v195, s[12:15], s56 offen offset:3072 lds
    v_exp_f32 v78, v78
    v_exp_f32 v79, v79
    v_cvt_pk_bf16_f32 v6, v72, v73
    v_cvt_pk_bf16_f32 v7, v74, v75
    v_cvt_pk_bf16_f32 v8, v76, v77
    v_cvt_pk_bf16_f32 v9, v78, v79
    v_exp_f32 v80, v80
    v_exp_f32 v81, v81
    v_mfma_f32_32x32x16_bf16 v[144:159], a[188:191], v[6:9], v[144:159]
    v_exp_f32 v82, v82
    v_exp_f32 v83, v83
    s_add_u32 m0, s59, 114688
    s_add_u32 s56, s84, 98304
    buffer_load_dwordx4 v192, s[12:15], s56 offen offset:0 lds
    buffer_load_dwordx4 a[96:99], v198, s[36:39], s55 offen offset:2048 sc1
    buffer_load_dwordx4 a[100:103], v199, s[36:39], s55 offen offset:2048 sc1
    v_exp_f32 v84, v84
    v_exp_f32 v85, v85
    v_mfma_f32_32x32x16_bf16 v[64:79], a[128:131], v[12:15], v[240:255]
    v_exp_f32 v86, v86
    v_exp_f32 v87, v87
    v_cvt_pk_bf16_f32 v2, v80, v81
    v_cvt_pk_bf16_f32 v3, v82, v83
    v_cvt_pk_bf16_f32 v4, v84, v85
    v_cvt_pk_bf16_f32 v5, v86, v87
    buffer_load_dwordx4 v193, s[12:15], s56 offen offset:1024 lds
    v_exp_f32_e64 v88, v88
    v_exp_f32 v89, v89
    s_waitcnt vmcnt(46)
    v_mfma_f32_32x32x16_bf16 v[160:175], a[176:179], v[2:5], v[160:175]
    v_exp_f32 v90, v90
    v_exp_f32 v91, v91
    v_exp_f32 v92, v92
    v_exp_f32 v93, v93
    buffer_load_dwordx4 v194, s[12:15], s56 offen offset:2048 lds
    buffer_load_dwordx4 a[104:107], v198, s[36:39], s55 offen offset:3072 sc1
    buffer_load_dwordx4 a[108:111], v199, s[36:39], s55 offen offset:3072 sc1
    v_exp_f32 v94, v94
    v_exp_f32 v95, v95
    v_cvt_pk_bf16_f32 v6, v88, v89
    v_cvt_pk_bf16_f32 v7, v90, v91
    v_cvt_pk_bf16_f32 v8, v92, v93
    v_cvt_pk_bf16_f32 v9, v94, v95
    v_exp_f32 v96, v96
    v_exp_f32 v97, v97
    v_mfma_f32_32x32x16_bf16 v[160:175], a[180:183], v[6:9], v[160:175]
    v_exp_f32 v98, v98
    v_exp_f32 v99, v99
    buffer_load_dwordx4 v195, s[12:15], s56 offen offset:3072 lds
    v_exp_f32 v100, v100
    v_exp_f32 v101, v101
    v_exp_f32 v102, v102
    v_exp_f32 v103, v103
    v_cvt_pk_bf16_f32 v2, v96, v97
    v_cvt_pk_bf16_f32 v3, v98, v99
    v_cvt_pk_bf16_f32 v4, v100, v101
    v_cvt_pk_bf16_f32 v5, v102, v103
    s_add_u32 s55, s76, 4096
    buffer_load_dwordx4 a[112:115], v198, s[36:39], s55 offen offset:0 sc1
    buffer_load_dwordx4 a[116:119], v199, s[36:39], s55 offen offset:0 sc1
    v_exp_f32 v104, v104
    v_exp_f32 v105, v105
    v_mfma_f32_32x32x16_bf16 v[144:159], a[176:179], v[2:5], v[144:159]
    v_exp_f32 v106, v106
    v_exp_f32 v107, v107
    v_exp_f32 v108, v108
    v_exp_f32 v109, v109
    v_exp_f32 v110, v110
    v_exp_f32 v111, v111
    v_cvt_pk_bf16_f32 v6, v104, v105
    v_cvt_pk_bf16_f32 v7, v106, v107
    v_cvt_pk_bf16_f32 v8, v108, v109
    v_cvt_pk_bf16_f32 v9, v110, v111
    v_exp_f32 v64, v64
    v_exp_f32 v65, v65
    v_mfma_f32_32x32x16_bf16 v[144:159], a[180:183], v[6:9], v[144:159]
    v_exp_f32 v66, v66
    v_exp_f32 v67, v67
    buffer_load_dwordx4 a[120:123], v198, s[36:39], s55 offen offset:1024 sc1
    buffer_load_dwordx4 a[124:127], v199, s[36:39], s55 offen offset:1024 sc1
    v_exp_f32 v68, v68
    v_exp_f32 v69, v69
    v_exp_f32 v70, v70
    v_exp_f32 v71, v71
    v_cvt_pk_bf16_f32 v2, v64, v65
    v_cvt_pk_bf16_f32 v3, v66, v67
    v_cvt_pk_bf16_f32 v4, v68, v69
    v_cvt_pk_bf16_f32 v5, v70, v71
    v_exp_f32_e64 v72, v72
    v_exp_f32 v73, v73
    s_waitcnt vmcnt(52)
    v_mfma_f32_32x32x16_bf16 v[144:159], a[168:171], v[2:5], v[144:159]
    v_exp_f32 v74, v74
    v_exp_f32 v75, v75
    v_exp_f32 v76, v76
    v_exp_f32 v77, v77
    v_exp_f32 v78, v78
    v_exp_f32 v79, v79
    v_cvt_pk_bf16_f32 v6, v72, v73
    v_cvt_pk_bf16_f32 v7, v74, v75
    v_cvt_pk_bf16_f32 v8, v76, v77
    v_cvt_pk_bf16_f32 v9, v78, v79
    s_nop 1
    v_mfma_f32_32x32x16_bf16 v[144:159], a[172:175], v[6:9], v[144:159]
    s_nop 11
    v_max3_f32 v22, |v144|, |v145|, |v160|
    v_max3_f32 v23, |v146|, |v147|, |v161|
    v_max3_f32 v22, |v148|, |v149|, v22
    v_max3_f32 v23, |v150|, |v151|, v23
    v_max3_f32 v22, |v162|, |v163|, v22
    v_max3_f32 v23, |v164|, |v165|, v23
    v_max3_f32 v22, |v166|, |v167|, v22
    v_min_f32 v20, v152, v168
    v_max_f32 v21, v152, v168
    v_max_f32_e64 v22, v22, v23
    v_cmp_le_f32 vcc, 0x21800000, v20
    s_nop 0
    s_mov_b64 s[56:57], vcc
    v_cmp_ge_f32 vcc, 0x5d800000, v21
    s_nop 0
    s_and_b64 s[56:57], s[56:57], vcc
    v_cmp_ge_f32 vcc, 0x7b800000, v22
    s_nop 0
    s_and_b64 s[56:57], s[56:57], vcc
    s_cmp_eq_u64 s[56:57], -1
    s_cbranch_scc0 SLOWATT
ATT_DONE:
    s_add_u32 s54, s77, 32768
    v_rcp_f32 v21, v168
    s_nop 0
    v_mul_f32 v160, v160, v21
    v_mul_f32 v161, v161, v21
    v_mul_f32 v162, v162, v21
    v_mul_f32 v163, v163, v21
    v_mul_f32 v164, v164, v21
    v_mul_f32 v165, v165, v21
    v_mul_f32 v166, v166, v21
    v_mul_f32 v167, v167, v21
    v_cvt_pk_bf16_f32 v16, v160, v161
    v_cvt_pk_bf16_f32 v17, v162, v163
    v_cvt_pk_bf16_f32 v18, v164, v165
    v_cvt_pk_bf16_f32 v19, v166, v167
    v_rcp_f32 v20, v152
    s_nop 0
    v_mul_f32 v144, v144, v20
    v_mul_f32 v145, v145, v20
    v_mul_f32 v146, v146, v20
    v_mul_f32 v147, v147, v20
    v_mul_f32 v148, v148, v20
    v_mul_f32 v149, v149, v20
    v_mul_f32 v150, v150, v20
    v_mul_f32 v151, v151, v20
    v_cvt_pk_bf16_f32 v12, v144, v145
    v_cvt_pk_bf16_f32 v13, v146, v147
    v_cvt_pk_bf16_f32 v14, v148, v149
    v_cvt_pk_bf16_f32 v15, v150, v151
    buffer_store_dwordx4 v[16:19], v60, s[36:39], s54 offen sc1
    buffer_store_dwordx4 v[12:15], v60, s[36:39], s77 offen sc1
    s_waitcnt vmcnt(19)
    v_mfma_f32_32x32x16_bf16 v[64:79], a[0:3], a[80:83], 0
    v_mfma_f32_32x32x16_bf16 v[80:95], a[0:3], a[84:87], 0
    v_mfma_f32_32x32x16_bf16 v[96:111], a[4:7], a[80:83], 0
    v_mfma_f32_32x32x16_bf16 v[112:127], a[4:7], a[84:87], 0
    buffer_load_dwordx4 a[80:83], v198, s[36:39], s55 offen offset:2048 sc1
    buffer_load_dwordx4 a[84:87], v199, s[36:39], s55 offen offset:2048 sc1
    s_waitcnt vmcnt(17)
    v_mfma_f32_32x32x16_bf16 v[64:79], a[8:11], a[88:91], v[64:79]
    v_mfma_f32_32x32x16_bf16 v[80:95], a[8:11], a[92:95], v[80:95]
    v_mfma_f32_32x32x16_bf16 v[96:111], a[12:15], a[88:91], v[96:111]
    v_mfma_f32_32x32x16_bf16 v[112:127], a[12:15], a[92:95], v[112:127]
    buffer_load_dwordx4 a[88:91], v198, s[36:39], s55 offen offset:3072 sc1
    buffer_load_dwordx4 a[92:95], v199, s[36:39], s55 offen offset:3072 sc1
    s_waitcnt vmcnt(15)
    v_mfma_f32_32x32x16_bf16 v[64:79], a[16:19], a[96:99], v[64:79]
    v_mfma_f32_32x32x16_bf16 v[80:95], a[16:19], a[100:103], v[80:95]
    v_mfma_f32_32x32x16_bf16 v[96:111], a[20:23], a[96:99], v[96:111]
    v_mfma_f32_32x32x16_bf16 v[112:127], a[20:23], a[100:103], v[112:127]
    s_add_u32 s55, s76, 8192
    buffer_load_dwordx4 a[96:99], v198, s[36:39], s55 offen offset:0 sc1
    buffer_load_dwordx4 a[100:103], v199, s[36:39], s55 offen offset:0 sc1
    s_waitcnt vmcnt(13)
    v_mfma_f32_32x32x16_bf16 v[64:79], a[24:27], a[104:107], v[64:79]
    v_mfma_f32_32x32x16_bf16 v[80:95], a[24:27], a[108:111], v[80:95]
    v_mfma_f32_32x32x16_bf16 v[96:111], a[28:31], a[104:107], v[96:111]
    v_mfma_f32_32x32x16_bf16 v[112:127], a[28:31], a[108:111], v[112:127]
    buffer_load_dwordx4 a[104:107], v198, s[36:39], s55 offen offset:1024 sc1
    buffer_load_dwordx4 a[108:111], v199, s[36:39], s55 offen offset:1024 sc1
    s_waitcnt vmcnt(8)
    s_atomic_add s53, s[36:37], s78
    v_mfma_f32_32x32x16_bf16 v[64:79], a[32:35], a[112:115], v[64:79]
    v_mfma_f32_32x32x16_bf16 v[80:95], a[32:35], a[116:119], v[80:95]
    v_mfma_f32_32x32x16_bf16 v[96:111], a[36:39], a[112:115], v[96:111]
    v_mfma_f32_32x32x16_bf16 v[112:127], a[36:39], a[116:119], v[112:127]
    buffer_load_dwordx4 a[112:115], v198, s[36:39], s55 offen offset:2048 sc1
    buffer_load_dwordx4 a[116:119], v199, s[36:39], s55 offen offset:2048 sc1
    v_mfma_f32_32x32x16_bf16 v[64:79], a[40:43], a[120:123], v[64:79]
    v_mfma_f32_32x32x16_bf16 v[80:95], a[40:43], a[124:127], v[80:95]
    s_add_u32 s57, s59, 131072
    v_add_u32 v216, s57, v60
    v_mfma_f32_32x32x16_bf16 v[96:111], a[44:47], a[120:123], v[96:111]
    s_xor_b32 s57, s57, 4096
    v_add_u32_e64 v219, s57, v60
    v_mfma_f32_32x32x16_bf16 v[112:127], a[44:47], a[124:127], v[112:127]
    buffer_load_dwordx4 a[120:123], v198, s[36:39], s55 offen offset:3072 sc1
    buffer_load_dwordx4 a[124:127], v199, s[36:39], s55 offen offset:3072 sc1
    s_waitcnt vmcnt(10)
    v_mfma_f32_32x32x16_bf16 v[64:79], a[48:51], a[80:83], v[64:79]
    v_mfma_f32_32x32x16_bf16 v[80:95], a[48:51], a[84:87], v[80:95]
    s_add_u32 s57, s59, 147456
    v_add_u32 v217, s57, v60
    v_mfma_f32_32x32x16_bf16 v[96:111], a[52:55], a[80:83], v[96:111]
    s_xor_b32 s57, s57, 8192
    v_add_u32_e64 v220, s57, v60
    v_mfma_f32_32x32x16_bf16 v[112:127], a[52:55], a[84:87], v[112:127]
    s_add_u32 s55, s76, 12288
    buffer_load_dwordx4 a[0:3], v198, s[36:39], s55 offen offset:0 sc1
    buffer_load_dwordx4 a[4:7], v199, s[36:39], s55 offen offset:0 sc1
    s_waitcnt vmcnt(10)
    v_mfma_f32_32x32x16_bf16 v[64:79], a[56:59], a[88:91], v[64:79]
    v_mfma_f32_32x32x16_bf16 v[80:95], a[56:59], a[92:95], v[80:95]
    s_add_u32 s57, s59, 49152
    v_add_u32 v218, s57, v60
    v_mfma_f32_32x32x16_bf16 v[96:111], a[60:63], a[88:91], v[96:111]
    s_xor_b32 s57, s57, 12288
    v_add_u32 v221, s57, v60
    v_mfma_f32_32x32x16_bf16 v[112:127], a[60:63], a[92:95], v[112:127]
    buffer_load_dwordx4 a[8:11], v198, s[36:39], s55 offen offset:1024 sc1
    buffer_load_dwordx4 a[12:15], v199, s[36:39], s55 offen offset:1024 sc1
    s_waitcnt vmcnt(10)
    v_mfma_f32_32x32x16_bf16 v[64:79], a[64:67], a[96:99], v[64:79]
    ds_read_b64_tr_b16 v[36:37], v58 offset:0
    ds_read_b64_tr_b16 v[38:39], v58 offset:1024
    ds_read_b64_tr_b16 v[40:41], v59 offset:0
    ds_read_b64_tr_b16 v[42:43], v59 offset:1024
    v_mfma_f32_32x32x16_bf16 v[80:95], a[64:67], a[100:103], v[80:95]
    v_lshlrev_b32_e64 v222, 8, v62
    v_lshrrev_b32 v223, 5, v0
    v_mfma_f32_32x32x16_bf16 v[96:111], a[68:71], a[96:99], v[96:111]
    v_lshl_add_u32 v222, v223, 4, v222
    v_mfma_f32_32x32x16_bf16 v[112:127], a[68:71], a[100:103], v[112:127]
    buffer_load_dwordx4 a[16:19], v198, s[36:39], s55 offen offset:2048 sc1
    buffer_load_dwordx4 a[20:23], v199, s[36:39], s55 offen offset:2048 sc1
    s_waitcnt vmcnt(10)
    v_mfma_f32_32x32x16_bf16 v[64:79], a[72:75], a[104:107], v[64:79]
    ds_read_b64_tr_b16 v[44:45], v58 offset:2048
    ds_read_b64_tr_b16 v[46:47], v58 offset:3072
    ds_read_b64_tr_b16 v[48:49], v59 offset:2048
    ds_read_b64_tr_b16 v[50:51], v59 offset:3072
    v_mfma_f32_32x32x16_bf16 v[80:95], a[72:75], a[108:111], v[80:95]
    v_mfma_f32_32x32x16_bf16 v[96:111], a[76:79], a[104:107], v[96:111]
    v_mfma_f32_32x32x16_bf16 v[112:127], a[76:79], a[108:111], v[112:127]
    buffer_load_dwordx4 a[24:27], v198, s[36:39], s55 offen offset:3072 sc1
    buffer_load_dwordx4 a[28:31], v199, s[36:39], s55 offen offset:3072 sc1
    s_waitcnt vmcnt(10)
    s_waitcnt lgkmcnt(4)
    v_mfma_f32_32x32x16_bf16 v[64:79], v[36:39], a[112:115], v[64:79]
    ds_read_b64_tr_b16 v[28:29], v58 offset:16384
    ds_read_b64_tr_b16 v[30:31], v58 offset:17408
    ds_read_b64_tr_b16 v[32:33], v59 offset:16384
    ds_read_b64_tr_b16 v[34:35], v59 offset:17408
    v_mfma_f32_32x32x16_bf16 v[80:95], v[36:39], a[116:119], v[80:95]
    v_mfma_f32_32x32x16_bf16 v[96:111], v[40:43], a[112:115], v[96:111]
    v_mfma_f32_32x32x16_bf16 v[112:127], v[40:43], a[116:119], v[112:127]
    s_add_u32 s55, s76, 16384
    buffer_load_dwordx4 a[32:35], v198, s[36:39], s55 offen offset:0 sc1
    buffer_load_dwordx4 a[36:39], v199, s[36:39], s55 offen offset:0 sc1
    s_waitcnt vmcnt(10)
    s_waitcnt lgkmcnt(4)
    v_mfma_f32_32x32x16_bf16 v[64:79], v[44:47], a[120:123], v[64:79]
    ds_read_b64_tr_b16 v[36:37], v58 offset:18432
    ds_read_b64_tr_b16 v[38:39], v58 offset:19456
    ds_read_b64_tr_b16 v[40:41], v59 offset:18432
    ds_read_b64_tr_b16 v[42:43], v59 offset:19456
    v_mfma_f32_32x32x16_bf16 v[80:95], v[44:47], a[124:127], v[80:95]
    v_mfma_f32_32x32x16_bf16 v[96:111], v[48:51], a[120:123], v[96:111]
    v_mfma_f32_32x32x16_bf16 v[112:127], v[48:51], a[124:127], v[112:127]
    buffer_load_dwordx4 a[40:43], v198, s[36:39], s55 offen offset:1024 sc1
    buffer_load_dwordx4 a[44:47], v199, s[36:39], s55 offen offset:1024 sc1
    s_waitcnt vmcnt(10)
    s_waitcnt lgkmcnt(4)
    v_mfma_f32_32x32x16_bf16 v[64:79], v[28:31], a[0:3], v[64:79]
    ds_read_b64_tr_b16 v[44:45], v196 offset:49152
    ds_read_b64_tr_b16 v[46:47], v196 offset:50176
    ds_read_b64_tr_b16 v[48:49], v197 offset:49152
    ds_read_b64_tr_b16 v[50:51], v197 offset:50176
    v_mfma_f32_32x32x16_bf16 v[80:95], v[28:31], a[4:7], v[80:95]
    v_mfma_f32_32x32x16_bf16 v[96:111], v[32:35], a[0:3], v[96:111]
    v_mfma_f32_32x32x16_bf16 v[112:127], v[32:35], a[4:7], v[112:127]
    buffer_load_dwordx4 a[48:51], v198, s[36:39], s55 offen offset:2048 sc1
    buffer_load_dwordx4 a[52:55], v199, s[36:39], s55 offen offset:2048 sc1
    s_waitcnt vmcnt(10)
    s_waitcnt lgkmcnt(4)
    v_mfma_f32_32x32x16_bf16 v[64:79], v[36:39], a[8:11], v[64:79]
    ds_read_b64_tr_b16 v[28:29], v196 offset:51200
    ds_read_b64_tr_b16 v[30:31], v196 offset:52224
    ds_read_b64_tr_b16 v[32:33], v197 offset:51200
    ds_read_b64_tr_b16 v[34:35], v197 offset:52224
    v_mfma_f32_32x32x16_bf16 v[80:95], v[36:39], a[12:15], v[80:95]
    v_mfma_f32_32x32x16_bf16 v[96:111], v[40:43], a[8:11], v[96:111]
    v_mfma_f32_32x32x16_bf16 v[112:127], v[40:43], a[12:15], v[112:127]
    buffer_load_dwordx4 a[56:59], v198, s[36:39], s55 offen offset:3072 sc1
    buffer_load_dwordx4 a[60:63], v199, s[36:39], s55 offen offset:3072 sc1
    s_waitcnt vmcnt(10)
    s_waitcnt lgkmcnt(4)
    v_mfma_f32_32x32x16_bf16 v[64:79], v[44:47], a[16:19], v[64:79]
    ds_read_b64_tr_b16 v[36:37], v56 offset:0
    ds_read_b64_tr_b16 v[38:39], v56 offset:1024
    ds_read_b64_tr_b16 v[40:41], v57 offset:0
    ds_read_b64_tr_b16 v[42:43], v57 offset:1024
    v_mfma_f32_32x32x16_bf16 v[80:95], v[44:47], a[20:23], v[80:95]
    v_mfma_f32_32x32x16_bf16 v[96:111], v[48:51], a[16:19], v[96:111]
    v_mfma_f32_32x32x16_bf16 v[112:127], v[48:51], a[20:23], v[112:127]
    s_add_u32 s55, s76, 20480
    buffer_load_dwordx4 a[64:67], v198, s[36:39], s55 offen offset:0 sc1
    buffer_load_dwordx4 a[68:71], v199, s[36:39], s55 offen offset:0 sc1
    s_mov_b32 s43, 0
    s_nop 0
    s_atomic_add s43, s[36:37], s79 glc
    s_waitcnt vmcnt(10)
    s_waitcnt lgkmcnt(4)
    v_mfma_f32_32x32x16_bf16 v[64:79], v[28:31], a[24:27], v[64:79]
    ds_read_b64_tr_b16 v[44:45], v56 offset:2048
    ds_read_b64_tr_b16 v[46:47], v56 offset:3072
    ds_read_b64_tr_b16 v[48:49], v57 offset:2048
    ds_read_b64_tr_b16 v[50:51], v57 offset:3072
    v_mfma_f32_32x32x16_bf16 v[80:95], v[28:31], a[28:31], v[80:95]
    v_mfma_f32_32x32x16_bf16 v[96:111], v[32:35], a[24:27], v[96:111]
    v_mfma_f32_32x32x16_bf16 v[112:127], v[32:35], a[28:31], v[112:127]
    s_cmp_ge_u32 s3, 2
    s_cselect_b32 s55, 0x40000000, s55
    buffer_load_dwordx4 a[72:75], v198, s[36:39], s55 offen offset:1024 sc1
    buffer_load_dwordx4 a[76:79], v199, s[36:39], s55 offen offset:1024 sc1
    s_waitcnt vmcnt(10)
    s_waitcnt lgkmcnt(4)
    v_mfma_f32_32x32x16_bf16 v[64:79], v[36:39], a[32:35], v[64:79]
    ds_read_b64_tr_b16 v[28:29], v56 offset:16384
    ds_read_b64_tr_b16 v[30:31], v56 offset:17408
    ds_read_b64_tr_b16 v[32:33], v57 offset:16384
    ds_read_b64_tr_b16 v[34:35], v57 offset:17408
    v_mfma_f32_32x32x16_bf16 v[80:95], v[36:39], a[36:39], v[80:95]
    v_mfma_f32_32x32x16_bf16 v[96:111], v[40:43], a[32:35], v[96:111]
    v_mfma_f32_32x32x16_bf16 v[112:127], v[40:43], a[36:39], v[112:127]
    s_waitcnt lgkmcnt(0)
    s_cmp_eq_u32 s43, 32
    s_cbranch_scc0 SQ16
SQ16_OK:
    s_waitcnt vmcnt(8)
    v_mfma_f32_32x32x16_bf16 v[64:79], v[44:47], a[40:43], v[64:79]
    ds_read_b64_tr_b16 v[36:37], v56 offset:18432
    ds_read_b64_tr_b16 v[38:39], v56 offset:19456
    ds_read_b64_tr_b16 v[40:41], v57 offset:18432
    ds_read_b64_tr_b16 v[42:43], v57 offset:19456
    v_mfma_f32_32x32x16_bf16 v[80:95], v[44:47], a[44:47], v[80:95]
    s_add_u32 s55, s80, 0
    buffer_load_dwordx4 a[128:131], v200, s[36:39], s55 offen offset:0 sc1
    buffer_load_dwordx4 a[132:135], v201, s[36:39], s55 offen offset:0 sc1
    v_mfma_f32_32x32x16_bf16 v[96:111], v[48:51], a[40:43], v[96:111]
    buffer_load_dword v22, v62, s[36:39], s81 offen sc1
    s_xor_b32 s54, s81, 128
    buffer_load_dword v24, v62, s[36:39], s54 offen sc1
    v_mfma_f32_32x32x16_bf16 v[112:127], v[48:51], a[44:47], v[112:127]
    buffer_load_dwordx4 a[136:139], v200, s[36:39], s55 offen offset:1024 sc1
    buffer_load_dwordx4 a[140:143], v201, s[36:39], s55 offen offset:1024 sc1
    s_waitcnt vmcnt(12)
    v_mfma_f32_32x32x16_bf16 v[64:79], v[28:31], a[48:51], v[64:79]
    ds_read_b64_tr_b16 v[44:45], v196 offset:0
    ds_read_b64_tr_b16 v[46:47], v196 offset:1024
    ds_read_b64_tr_b16 v[48:49], v197 offset:0
    ds_read_b64_tr_b16 v[50:51], v197 offset:1024
    v_mfma_f32_32x32x16_bf16 v[80:95], v[28:31], a[52:55], v[80:95]
    buffer_load_dwordx4 a[144:147], v200, s[36:39], s55 offen offset:2048 sc1
    buffer_load_dwordx4 a[148:151], v201, s[36:39], s55 offen offset:2048 sc1
    v_mfma_f32_32x32x16_bf16 v[96:111], v[32:35], a[48:51], v[96:111]
    v_mfma_f32_32x32x16_bf16 v[112:127], v[32:35], a[52:55], v[112:127]
    buffer_load_dwordx4 a[152:155], v200, s[36:39], s55 offen offset:3072 sc1
    buffer_load_dwordx4 a[156:159], v201, s[36:39], s55 offen offset:3072 sc1
    s_waitcnt vmcnt(14)
    s_waitcnt lgkmcnt(4)
    v_mfma_f32_32x32x16_bf16 v[64:79], v[36:39], a[56:59], v[64:79]
    ds_read_b64_tr_b16 v[28:29], v196 offset:2048
    ds_read_b64_tr_b16 v[30:31], v196 offset:3072
    ds_read_b64_tr_b16 v[32:33], v197 offset:2048
    ds_read_b64_tr_b16 v[34:35], v197 offset:3072
    v_mfma_f32_32x32x16_bf16 v[80:95], v[36:39], a[60:63], v[80:95]
    s_add_u32 s55, s80, 4096
    buffer_load_dwordx4 a[160:163], v200, s[36:39], s55 offen offset:0 sc1
    buffer_load_dwordx4 a[164:167], v201, s[36:39], s55 offen offset:0 sc1
    v_mfma_f32_32x32x16_bf16 v[96:111], v[40:43], a[56:59], v[96:111]
    v_mfma_f32_32x32x16_bf16 v[112:127], v[40:43], a[60:63], v[112:127]
    buffer_load_dwordx4 a[168:171], v200, s[36:39], s55 offen offset:1024 sc1
    buffer_load_dwordx4 a[172:175], v201, s[36:39], s55 offen offset:1024 sc1
    s_waitcnt vmcnt(16)
    s_waitcnt lgkmcnt(4)
    v_mfma_f32_32x32x16_bf16 v[64:79], v[44:47], a[64:67], v[64:79]
    ds_read_b64_tr_b16 v[36:37], v196 offset:16384
    ds_read_b64_tr_b16 v[38:39], v196 offset:17408
    ds_read_b64_tr_b16 v[40:41], v197 offset:16384
    ds_read_b64_tr_b16 v[42:43], v197 offset:17408
    v_mfma_f32_32x32x16_bf16 v[80:95], v[44:47], a[68:71], v[80:95]
    v_mfma_f32_32x32x16_bf16 v[96:111], v[48:51], a[64:67], v[96:111]
    v_mfma_f32_32x32x16_bf16 v[112:127], v[48:51], a[68:71], v[112:127]
    buffer_load_dwordx4 a[176:179], v200, s[36:39], s55 offen offset:2048 sc1
    buffer_load_dwordx4 a[180:183], v201, s[36:39], s55 offen offset:2048 sc1
    s_waitcnt vmcnt(16)
    s_waitcnt lgkmcnt(4)
    v_mfma_f32_32x32x16_bf16 v[64:79], v[28:31], a[72:75], v[64:79]
    ds_read_b64_tr_b16 v[44:45], v196 offset:18432
    ds_read_b64_tr_b16 v[46:47], v196 offset:19456
    ds_read_b64_tr_b16 v[48:49], v197 offset:18432
    ds_read_b64_tr_b16 v[50:51], v197 offset:19456
    v_mfma_f32_32x32x16_bf16 v[80:95], v[28:31], a[76:79], v[80:95]
    v_mfma_f32_32x32x16_bf16 v[96:111], v[32:35], a[72:75], v[96:111]
    v_mfma_f32_32x32x16_bf16 v[112:127], v[32:35], a[76:79], v[112:127]
    buffer_load_dwordx4 a[184:187], v200, s[36:39], s55 offen offset:3072 sc1
    buffer_load_dwordx4 a[188:191], v201, s[36:39], s55 offen offset:3072 sc1
    s_waitcnt vmcnt(16)
    s_waitcnt lgkmcnt(4)
    v_mfma_f32_32x32x16_bf16 v[128:143], v[36:39], a[128:131], 0
    ds_read_b64_tr_b16 v[28:29], v196 offset:32768
    ds_read_b64_tr_b16 v[30:31], v196 offset:33792
    ds_read_b64_tr_b16 v[32:33], v197 offset:32768
    ds_read_b64_tr_b16 v[34:35], v197 offset:33792
    v_mfma_f32_32x32x16_bf16 v[144:159], v[36:39], a[132:135], 0
    v_mfma_f32_32x32x16_bf16 v[160:175], v[40:43], a[128:131], 0
    v_mfma_f32_32x32x16_bf16 v[176:191], v[40:43], a[132:135], 0
    s_waitcnt vmcnt(12)
    s_waitcnt lgkmcnt(4)
    v_mfma_f32_32x32x16_bf16 v[128:143], v[44:47], a[136:139], v[128:143]
    ds_read_b64_tr_b16 v[36:37], v196 offset:34816
    ds_read_b64_tr_b16 v[38:39], v196 offset:35840
    ds_read_b64_tr_b16 v[40:41], v197 offset:34816
    ds_read_b64_tr_b16 v[42:43], v197 offset:35840
    v_sub_f32 v20, 1.0, v22
    v_sub_f32 v21, 1.0, v24
    v_mfma_f32_32x32x16_bf16 v[144:159], v[44:47], a[140:143], v[144:159]
    v_mul_f32 v64, v64, v20
    v_mul_f32 v65, v65, v20
    v_mfma_f32_32x32x16_bf16 v[160:175], v[48:51], a[136:139], v[160:175]
    v_mul_f32 v66, v66, v20
    v_mul_f32 v67, v67, v20
    v_mfma_f32_32x32x16_bf16 v[176:191], v[48:51], a[140:143], v[176:191]
    v_mul_f32 v68, v68, v20
    v_mul_f32 v69, v69, v20
    s_waitcnt vmcnt(10)
    s_waitcnt lgkmcnt(4)
    v_mfma_f32_32x32x16_bf16 v[128:143], v[28:31], a[144:147], v[128:143]
    ds_read_b64_tr_b16 v[44:45], v56 offset:32768
    ds_read_b64_tr_b16 v[46:47], v56 offset:33792
    ds_read_b64_tr_b16 v[48:49], v57 offset:32768
    ds_read_b64_tr_b16 v[50:51], v57 offset:33792
    v_mfma_f32_32x32x16_bf16 v[144:159], v[28:31], a[148:151], v[144:159]
    v_mul_f32 v70, v70, v20
    v_mul_f32 v71, v71, v20
    v_mfma_f32_32x32x16_bf16 v[160:175], v[32:35], a[144:147], v[160:175]
    v_mul_f32 v72, v72, v20
    v_mul_f32 v73, v73, v20
    v_mfma_f32_32x32x16_bf16 v[176:191], v[32:35], a[148:151], v[176:191]
    v_mul_f32 v74, v74, v20
    v_mul_f32 v75, v75, v20
    s_waitcnt vmcnt(8)
    s_waitcnt lgkmcnt(4)
    v_mfma_f32_32x32x16_bf16 v[128:143], v[36:39], a[152:155], v[128:143]
    ds_read_b64_tr_b16 v[28:29], v56 offset:34816
    ds_read_b64_tr_b16 v[30:31], v56 offset:35840
    ds_read_b64_tr_b16 v[32:33], v57 offset:34816
    ds_read_b64_tr_b16 v[34:35], v57 offset:35840
    v_mfma_f32_32x32x16_bf16 v[144:159], v[36:39], a[156:159], v[144:159]
    v_mul_f32 v76, v76, v20
    v_mul_f32 v77, v77, v20
    v_mul_f32 v78, v78, v20
    v_mul_f32 v79, v79, v20
    v_mfma_f32_32x32x16_bf16 v[160:175], v[40:43], a[152:155], v[160:175]
    v_mul_f32 v80, v80, v21
    v_mul_f32 v81, v81, v21
    v_mul_f32 v82, v82, v21
    v_mul_f32 v83, v83, v21
    v_mfma_f32_32x32x16_bf16 v[176:191], v[40:43], a[156:159], v[176:191]
    v_mul_f32 v84, v84, v21
    v_mul_f32 v85, v85, v21
    v_mul_f32 v86, v86, v21
    v_mul_f32 v87, v87, v21
    s_waitcnt vmcnt(6)
    s_waitcnt lgkmcnt(4)
    v_mfma_f32_32x32x16_bf16 v[128:143], v[44:47], a[160:163], v[128:143]
    ds_read_b64_tr_b16 v[36:37], v56 offset:49152
    ds_read_b64_tr_b16 v[38:39], v56 offset:50176
    ds_read_b64_tr_b16 v[40:41], v57 offset:49152
    ds_read_b64_tr_b16 v[42:43], v57 offset:50176
    v_mfma_f32_32x32x16_bf16 v[144:159], v[44:47], a[164:167], v[144:159]
    v_mul_f32 v88, v88, v21
    v_mul_f32 v89, v89, v21
    v_mul_f32 v90, v90, v21
    v_mul_f32 v91, v91, v21
    v_mfma_f32_32x32x16_bf16 v[160:175], v[48:51], a[160:163], v[160:175]
    v_mul_f32 v92, v92, v21
    v_mul_f32 v93, v93, v21
    v_mul_f32 v94, v94, v21
    v_mul_f32 v95, v95, v21
    v_mfma_f32_32x32x16_bf16 v[176:191], v[48:51], a[164:167], v[176:191]
    v_mul_f32 v96, v96, v20
    v_mul_f32 v97, v97, v20
    v_mul_f32 v98, v98, v20
    v_mul_f32 v99, v99, v20
    s_waitcnt vmcnt(4)
    s_waitcnt lgkmcnt(4)
    v_mfma_f32_32x32x16_bf16 v[128:143], v[28:31], a[168:171], v[128:143]
    ds_read_b64_tr_b16 v[44:45], v56 offset:51200
    ds_read_b64_tr_b16 v[46:47], v56 offset:52224
    ds_read_b64_tr_b16 v[48:49], v57 offset:51200
    ds_read_b64_tr_b16 v[50:51], v57 offset:52224
    v_mfma_f32_32x32x16_bf16 v[144:159], v[28:31], a[172:175], v[144:159]
    v_mul_f32 v100, v100, v20
    v_mul_f32 v101, v101, v20
    v_mul_f32 v102, v102, v20
    v_mul_f32 v103, v103, v20
    v_mfma_f32_32x32x16_bf16 v[160:175], v[32:35], a[168:171], v[160:175]
    v_mul_f32 v104, v104, v20
    v_mul_f32 v105, v105, v20
    v_mul_f32 v106, v106, v20
    v_mul_f32 v107, v107, v20
    v_mfma_f32_32x32x16_bf16 v[176:191], v[32:35], a[172:175], v[176:191]
    v_mul_f32 v108, v108, v20
    v_mul_f32 v109, v109, v20
    v_mul_f32 v110, v110, v20
    v_mul_f32 v111, v111, v20
    s_waitcnt vmcnt(2)
    s_waitcnt lgkmcnt(4)
    v_mfma_f32_32x32x16_bf16 v[128:143], v[36:39], a[176:179], v[128:143]
    v_mfma_f32_32x32x16_bf16 v[144:159], v[36:39], a[180:183], v[144:159]
    v_mul_f32 v112, v112, v21
    v_mul_f32 v113, v113, v21
    v_mul_f32 v114, v114, v21
    v_mul_f32 v115, v115, v21
    v_mfma_f32_32x32x16_bf16 v[160:175], v[40:43], a[176:179], v[160:175]
    v_mul_f32 v116, v116, v21
    v_mul_f32 v117, v117, v21
    v_mul_f32 v118, v118, v21
    v_mul_f32 v119, v119, v21
    v_mfma_f32_32x32x16_bf16 v[176:191], v[40:43], a[180:183], v[176:191]
    v_mul_f32 v120, v120, v21
    v_mul_f32 v121, v121, v21
    v_mul_f32 v122, v122, v21
    v_mul_f32 v123, v123, v21
    s_waitcnt vmcnt(0)
    s_waitcnt lgkmcnt(0)
    v_mfma_f32_32x32x16_bf16 v[128:143], v[44:47], a[184:187], v[128:143]
    v_mfma_f32_32x32x16_bf16 v[144:159], v[44:47], a[188:191], v[144:159]
    v_mul_f32 v124, v124, v21
    v_mul_f32 v125, v125, v21
    v_mul_f32 v126, v126, v21
    v_mul_f32 v127, v127, v21
    v_mfma_f32_32x32x16_bf16 v[160:175], v[48:51], a[184:187], v[160:175]
    v_mfma_f32_32x32x16_bf16 v[176:191], v[48:51], a[188:191], v[176:191]
    v_mov_b32_e64 v23, v22
    v_mov_b32 v25, v24
    s_nop 3
    v_pk_fma_f32 v[80:81], v[144:145], v[24:25], v[80:81]
    v_pk_fma_f32 v[82:83], v[146:147], v[24:25], v[82:83]
    ds_write_b128 v216, v[80:83] offset:0
    v_pk_fma_f32 v[84:85], v[148:149], v[24:25], v[84:85]
    v_pk_fma_f32 v[86:87], v[150:151], v[24:25], v[86:87]
    ds_write_b128 v216, v[84:87] offset:1024
    v_pk_fma_f32 v[88:89], v[152:153], v[24:25], v[88:89]
    v_pk_fma_f32 v[90:91], v[154:155], v[24:25], v[90:91]
    ds_write_b128 v216, v[88:91] offset:2048
    v_pk_fma_f32 v[92:93], v[156:157], v[24:25], v[92:93]
    v_pk_fma_f32 v[94:95], v[158:159], v[24:25], v[94:95]
    ds_write_b128 v216, v[92:95] offset:3072
    v_pk_fma_f32 v[96:97], v[160:161], v[22:23], v[96:97]
    v_pk_fma_f32 v[98:99], v[162:163], v[22:23], v[98:99]
    ds_write_b128 v217, v[96:99] offset:0
    v_pk_fma_f32 v[100:101], v[164:165], v[22:23], v[100:101]
    v_pk_fma_f32 v[102:103], v[166:167], v[22:23], v[102:103]
    ds_write_b128 v217, v[100:103] offset:1024
    v_pk_fma_f32 v[104:105], v[168:169], v[22:23], v[104:105]
    v_pk_fma_f32 v[106:107], v[170:171], v[22:23], v[106:107]
    ds_write_b128 v217, v[104:107] offset:2048
    v_pk_fma_f32 v[108:109], v[172:173], v[22:23], v[108:109]
    v_pk_fma_f32 v[110:111], v[174:175], v[22:23], v[110:111]
    ds_write_b128 v217, v[108:111] offset:3072
    v_pk_fma_f32 v[112:113], v[176:177], v[24:25], v[112:113]
    v_pk_fma_f32 v[114:115], v[178:179], v[24:25], v[114:115]
    ds_write_b128 v218, v[112:115] offset:0
    v_pk_fma_f32 v[116:117], v[180:181], v[24:25], v[116:117]
    v_pk_fma_f32 v[118:119], v[182:183], v[24:25], v[118:119]
    ds_write_b128 v218, v[116:119] offset:1024
    v_pk_fma_f32 v[120:121], v[184:185], v[24:25], v[120:121]
    v_pk_fma_f32 v[122:123], v[186:187], v[24:25], v[122:123]
    ds_write_b128 v218, v[120:123] offset:2048
    v_pk_fma_f32 v[124:125], v[188:189], v[24:25], v[124:125]
    v_pk_fma_f32 v[126:127], v[190:191], v[24:25], v[126:127]
    ds_write_b128 v218, v[124:127] offset:3072
    v_pk_fma_f32 v[64:65], v[128:129], v[22:23], v[64:65]
    v_pk_fma_f32 v[66:67], v[130:131], v[22:23], v[66:67]
    v_pk_fma_f32 v[68:69], v[132:133], v[22:23], v[68:69]
    v_pk_fma_f32 v[70:71], v[134:135], v[22:23], v[70:71]
    v_pk_fma_f32 v[72:73], v[136:137], v[22:23], v[72:73]
    v_pk_fma_f32 v[74:75], v[138:139], v[22:23], v[74:75]
    v_pk_fma_f32 v[76:77], v[140:141], v[22:23], v[76:77]
    v_pk_fma_f32 v[78:79], v[142:143], v[22:23], v[78:79]
    s_waitcnt lgkmcnt(0)
    s_barrier
    ds_read_b128 v[144:147], v219 offset:0
    ds_read_b128 v[160:163], v220 offset:0
    ds_read_b128 v[176:179], v221 offset:0
    ds_read_b128 v[148:151], v219 offset:1024
    ds_read_b128 v[164:167], v220 offset:1024
    ds_read_b128 v[180:183], v221 offset:1024
    ds_read_b128 v[152:155], v219 offset:2048
    ds_read_b128 v[168:171], v220 offset:2048
    ds_read_b128 v[184:187], v221 offset:2048
    ds_read_b128 v[156:159], v219 offset:3072
    ds_read_b128 v[172:175], v220 offset:3072
    ds_read_b128 v[188:191], v221 offset:3072
    s_waitcnt lgkmcnt(6)
    s_nop 0
    v_pk_add_f32 v[64:65], v[64:65], v[144:145]
    v_pk_add_f32 v[160:161], v[160:161], v[176:177]
    v_pk_add_f32 v[66:67], v[66:67], v[146:147]
    v_pk_add_f32 v[162:163], v[162:163], v[178:179]
    v_pk_add_f32 v[68:69], v[68:69], v[148:149]
    v_pk_add_f32 v[164:165], v[164:165], v[180:181]
    v_pk_add_f32 v[70:71], v[70:71], v[150:151]
    v_pk_add_f32 v[166:167], v[166:167], v[182:183]
    v_pk_add_f32 v[64:65], v[64:65], v[160:161]
    v_pk_add_f32 v[66:67], v[66:67], v[162:163]
    v_pk_add_f32 v[68:69], v[68:69], v[164:165]
    v_pk_add_f32 v[70:71], v[70:71], v[166:167]
    v_cvt_pk_bf16_f32 v208, v64, v65
    v_cvt_pk_bf16_f32 v209, v66, v67
    v_cvt_pk_bf16_f32 v210, v68, v69
    v_cvt_pk_bf16_f32 v211, v70, v71
    s_nop 0
    v_permlane32_swap_b32 v208, v210
    v_permlane32_swap_b32 v209, v211
    buffer_store_dwordx4 v[208:211], v222, s[32:35], s82 offen offset:0
    s_waitcnt lgkmcnt(0)
    v_pk_add_f32 v[72:73], v[72:73], v[152:153]
    v_pk_add_f32 v[168:169], v[168:169], v[184:185]
    v_pk_add_f32 v[74:75], v[74:75], v[154:155]
    v_pk_add_f32 v[170:171], v[170:171], v[186:187]
    v_pk_add_f32 v[76:77], v[76:77], v[156:157]
    v_pk_add_f32 v[172:173], v[172:173], v[188:189]
    v_pk_add_f32 v[78:79], v[78:79], v[158:159]
    v_pk_add_f32 v[174:175], v[174:175], v[190:191]
    v_pk_add_f32 v[72:73], v[72:73], v[168:169]
    v_pk_add_f32 v[74:75], v[74:75], v[170:171]
    v_pk_add_f32 v[76:77], v[76:77], v[172:173]
    v_pk_add_f32 v[78:79], v[78:79], v[174:175]
    v_cvt_pk_bf16_f32 v212, v72, v73
    v_cvt_pk_bf16_f32 v213, v74, v75
    v_cvt_pk_bf16_f32 v214, v76, v77
    v_cvt_pk_bf16_f32 v215, v78, v79
    s_nop 0
    v_permlane32_swap_b32 v212, v214
    v_permlane32_swap_b32 v213, v215
    buffer_store_dwordx4 v[212:215], v222, s[32:35], s82 offen offset:32
END:
    s_endpgm
CLR:
    v_lshlrev_b32_e64 v176, 7, v0
    s_mov_b32 s54, 15728640
    s_mov_b32 s55, 15736832
    s_mov_b32 s56, 15745024
    buffer_store_dword v63, v176, s[36:39], s54 offen sc1
    buffer_store_dword v63, v176, s[36:39], s55 offen sc1
    buffer_store_dword v63, v176, s[36:39], s56 offen sc1
    s_branch NOCLR
GOK:
    s_mov_b64 exec, 1
    global_store_dword v63, v206, s[40:41] sc1
    s_mov_b64 exec, -1
    s_branch NOGOK
GOV:
    s_mov_b64 exec, 1
    global_store_dword v63, v206, s[40:41] sc1
    s_mov_b64 exec, -1
    s_branch NOGOV
SP1:
    s_mov_b32 s58, 0x40000
SP1_L:
    global_load_dword v207, v63, s[40:41] sc1
    s_waitcnt vmcnt(0)
    v_cmp_eq_u32 vcc, 1, v207
    s_nop 0
    s_cmp_eq_u64 vcc, -1
    s_cbranch_scc1 SP1_OK
    s_sleep 1
    s_sub_u32 s58, s58, 1
    s_cmp_lg_u32 s58, 0
    s_cbranch_scc1 SP1_L
    s_endpgm
SQ2:
    s_mov_b32 s58, 0x20000
SQ2_L:
    s_sleep 2
    s_mov_b32 s43, 0
    s_atomic_add s43, s[36:37], s68 glc
    s_mov_b32 s46, 0
    s_atomic_add s46, s[36:37], s51 glc
    s_mov_b32 s47, 0
    s_atomic_add s47, s[36:37], s52 glc
    s_waitcnt lgkmcnt(0)
    s_and_b32 s43, s43, s46
    s_and_b32 s43, s43, s47
    s_cmp_eq_u32 s43, 8
    s_cbranch_scc1 SQ2_OK
    s_sub_u32 s58, s58, 1
    s_cmp_lg_u32 s58, 0
    s_cbranch_scc1 SQ2_L
    s_endpgm
SW3:
    v_pk_mov_b32 v[208:209], v[10:11], v[10:11]
    v_pk_mov_b32 v[210:211], v[10:11], v[10:11]
    v_pk_mov_b32 v[212:213], v[10:11], v[10:11]
    v_pk_mov_b32 v[214:215], v[10:11], v[10:11]
    v_pk_mov_b32 v[216:217], v[10:11], v[10:11]
    v_pk_mov_b32 v[218:219], v[10:11], v[10:11]
    v_pk_mov_b32 v[220:221], v[10:11], v[10:11]
    v_pk_mov_b32 v[222:223], v[10:11], v[10:11]
    s_nop 1
    s_branch SW3_R
SW4:
    v_pk_mov_b32 v[208:209], v[10:11], v[10:11]
    v_pk_mov_b32 v[210:211], v[10:11], v[10:11]
    v_pk_mov_b32 v[212:213], v[10:11], v[10:11]
    v_pk_mov_b32 v[214:215], v[10:11], v[10:11]
    v_pk_mov_b32 v[216:217], v[10:11], v[10:11]
    v_pk_mov_b32 v[218:219], v[10:11], v[10:11]
    v_pk_mov_b32 v[220:221], v[10:11], v[10:11]
    v_pk_mov_b32 v[222:223], v[10:11], v[10:11]
    s_nop 1
    s_branch SW4_R
SW5:
    v_pk_mov_b32 v[208:209], v[10:11], v[10:11]
    v_pk_mov_b32 v[210:211], v[10:11], v[10:11]
    v_pk_mov_b32 v[212:213], v[10:11], v[10:11]
    v_pk_mov_b32 v[214:215], v[10:11], v[10:11]
    v_pk_mov_b32 v[216:217], v[10:11], v[10:11]
    v_pk_mov_b32 v[218:219], v[10:11], v[10:11]
    v_pk_mov_b32 v[220:221], v[10:11], v[10:11]
    v_pk_mov_b32 v[222:223], v[10:11], v[10:11]
    s_nop 1
    s_branch SW5_R
SW6:
    v_pk_mov_b32 v[208:209], v[10:11], v[10:11]
    v_pk_mov_b32 v[210:211], v[10:11], v[10:11]
    v_pk_mov_b32 v[212:213], v[10:11], v[10:11]
    v_pk_mov_b32 v[214:215], v[10:11], v[10:11]
    v_pk_mov_b32 v[216:217], v[10:11], v[10:11]
    v_pk_mov_b32 v[218:219], v[10:11], v[10:11]
    v_pk_mov_b32 v[220:221], v[10:11], v[10:11]
    v_pk_mov_b32 v[222:223], v[10:11], v[10:11]
    s_nop 1
    s_branch SW6_R
SQ7:
    s_mov_b32 s58, 0x20000
SQ7_L:
    s_sleep 2
    s_mov_b32 s43, 0
    s_atomic_add s43, s[36:37], s75 glc
    s_waitcnt lgkmcnt(0)
    s_cmp_eq_u32 s43, 32
    s_cbranch_scc1 SQ7_OK
    s_sub_u32 s58, s58, 1
    s_cmp_lg_u32 s58, 0
    s_cbranch_scc1 SQ7_L
    s_endpgm
SW8:
    s_nop 0
    v_pk_mov_b32 v[208:209], v[10:11], v[10:11]
    v_pk_mov_b32 v[210:211], v[10:11], v[10:11]
    v_pk_mov_b32 v[212:213], v[10:11], v[10:11]
    v_pk_mov_b32 v[214:215], v[10:11], v[10:11]
    v_pk_mov_b32 v[216:217], v[10:11], v[10:11]
    v_pk_mov_b32 v[218:219], v[10:11], v[10:11]
    v_pk_mov_b32 v[220:221], v[10:11], v[10:11]
    v_pk_mov_b32 v[222:223], v[10:11], v[10:11]
    s_nop 1
    s_branch SW8_R
SW9:
    v_pk_mov_b32 v[208:209], v[10:11], v[10:11]
    v_pk_mov_b32 v[210:211], v[10:11], v[10:11]
    v_pk_mov_b32 v[212:213], v[10:11], v[10:11]
    v_pk_mov_b32 v[214:215], v[10:11], v[10:11]
    v_pk_mov_b32 v[216:217], v[10:11], v[10:11]
    v_pk_mov_b32 v[218:219], v[10:11], v[10:11]
    v_pk_mov_b32 v[220:221], v[10:11], v[10:11]
    v_pk_mov_b32 v[222:223], v[10:11], v[10:11]
    s_nop 1
    s_branch SW9_R
SW10:
    v_pk_mov_b32 v[208:209], v[10:11], v[10:11]
    v_pk_mov_b32 v[210:211], v[10:11], v[10:11]
    v_pk_mov_b32 v[212:213], v[10:11], v[10:11]
    v_pk_mov_b32 v[214:215], v[10:11], v[10:11]
    v_pk_mov_b32 v[216:217], v[10:11], v[10:11]
    v_pk_mov_b32 v[218:219], v[10:11], v[10:11]
    v_pk_mov_b32 v[220:221], v[10:11], v[10:11]
    v_pk_mov_b32 v[222:223], v[10:11], v[10:11]
    s_nop 1
    s_branch SW10_R
SW11:
    v_pk_mov_b32 v[208:209], v[10:11], v[10:11]
    v_pk_mov_b32 v[210:211], v[10:11], v[10:11]
    v_pk_mov_b32 v[212:213], v[10:11], v[10:11]
    v_pk_mov_b32 v[214:215], v[10:11], v[10:11]
    v_pk_mov_b32 v[216:217], v[10:11], v[10:11]
    v_pk_mov_b32 v[218:219], v[10:11], v[10:11]
    v_pk_mov_b32 v[220:221], v[10:11], v[10:11]
    v_pk_mov_b32 v[222:223], v[10:11], v[10:11]
    s_nop 1
    s_branch SW11_R
SW12:
    v_pk_mov_b32 v[112:113], v[10:11], v[10:11]
    v_pk_mov_b32 v[114:115], v[10:11], v[10:11]
    v_pk_mov_b32 v[116:117], v[10:11], v[10:11]
    v_pk_mov_b32 v[118:119], v[10:11], v[10:11]
    v_pk_mov_b32 v[120:121], v[10:11], v[10:11]
    v_pk_mov_b32 v[122:123], v[10:11], v[10:11]
    v_pk_mov_b32 v[124:125], v[10:11], v[10:11]
    v_pk_mov_b32 v[126:127], v[10:11], v[10:11]
    v_pk_mov_b32 v[128:129], v[10:11], v[10:11]
    v_pk_mov_b32 v[130:131], v[10:11], v[10:11]
    v_pk_mov_b32 v[132:133], v[10:11], v[10:11]
    v_pk_mov_b32 v[134:135], v[10:11], v[10:11]
    v_pk_mov_b32 v[136:137], v[10:11], v[10:11]
    v_pk_mov_b32 v[138:139], v[10:11], v[10:11]
    v_pk_mov_b32 v[140:141], v[10:11], v[10:11]
    v_pk_mov_b32 v[142:143], v[10:11], v[10:11]
    s_nop 1
    s_branch SW12_R
SW13:
    v_pk_mov_b32 v[112:113], v[10:11], v[10:11]
    v_pk_mov_b32 v[114:115], v[10:11], v[10:11]
    v_pk_mov_b32 v[116:117], v[10:11], v[10:11]
    v_pk_mov_b32 v[118:119], v[10:11], v[10:11]
    v_pk_mov_b32 v[120:121], v[10:11], v[10:11]
    v_pk_mov_b32 v[122:123], v[10:11], v[10:11]
    v_pk_mov_b32 v[124:125], v[10:11], v[10:11]
    v_pk_mov_b32 v[126:127], v[10:11], v[10:11]
    v_pk_mov_b32 v[128:129], v[10:11], v[10:11]
    v_pk_mov_b32 v[130:131], v[10:11], v[10:11]
    v_pk_mov_b32 v[132:133], v[10:11], v[10:11]
    v_pk_mov_b32 v[134:135], v[10:11], v[10:11]
    v_pk_mov_b32 v[136:137], v[10:11], v[10:11]
    v_pk_mov_b32 v[138:139], v[10:11], v[10:11]
    v_pk_mov_b32 v[140:141], v[10:11], v[10:11]
    v_pk_mov_b32 v[142:143], v[10:11], v[10:11]
    s_nop 1
    s_branch SW13_R
SW14:
    v_pk_mov_b32 v[112:113], v[10:11], v[10:11]
    v_pk_mov_b32 v[114:115], v[10:11], v[10:11]
    v_pk_mov_b32 v[116:117], v[10:11], v[10:11]
    v_pk_mov_b32 v[118:119], v[10:11], v[10:11]
    v_pk_mov_b32 v[120:121], v[10:11], v[10:11]
    v_pk_mov_b32 v[122:123], v[10:11], v[10:11]
    v_pk_mov_b32 v[124:125], v[10:11], v[10:11]
    v_pk_mov_b32 v[126:127], v[10:11], v[10:11]
    v_pk_mov_b32 v[128:129], v[10:11], v[10:11]
    v_pk_mov_b32 v[130:131], v[10:11], v[10:11]
    v_pk_mov_b32 v[132:133], v[10:11], v[10:11]
    v_pk_mov_b32 v[134:135], v[10:11], v[10:11]
    v_pk_mov_b32 v[136:137], v[10:11], v[10:11]
    v_pk_mov_b32 v[138:139], v[10:11], v[10:11]
    v_pk_mov_b32 v[140:141], v[10:11], v[10:11]
    v_pk_mov_b32 v[142:143], v[10:11], v[10:11]
    s_nop 1
    s_branch SW14_R
SW15:
    v_pk_mov_b32 v[112:113], v[10:11], v[10:11]
    v_pk_mov_b32 v[114:115], v[10:11], v[10:11]
    v_pk_mov_b32 v[116:117], v[10:11], v[10:11]
    v_pk_mov_b32 v[118:119], v[10:11], v[10:11]
    v_pk_mov_b32 v[120:121], v[10:11], v[10:11]
    v_pk_mov_b32 v[122:123], v[10:11], v[10:11]
    v_pk_mov_b32 v[124:125], v[10:11], v[10:11]
    v_pk_mov_b32 v[126:127], v[10:11], v[10:11]
    v_pk_mov_b32 v[128:129], v[10:11], v[10:11]
    v_pk_mov_b32 v[130:131], v[10:11], v[10:11]
    v_pk_mov_b32 v[132:133], v[10:11], v[10:11]
    v_pk_mov_b32 v[134:135], v[10:11], v[10:11]
    v_pk_mov_b32 v[136:137], v[10:11], v[10:11]
    v_pk_mov_b32 v[138:139], v[10:11], v[10:11]
    v_pk_mov_b32 v[140:141], v[10:11], v[10:11]
    v_pk_mov_b32 v[142:143], v[10:11], v[10:11]
    s_nop 1
    s_branch SW15_R
SQ16:
    s_mov_b32 s58, 0x20000
SQ16_L:
    s_sleep 2
    s_mov_b32 s43, 0
    s_atomic_add s43, s[36:37], s79 glc
    s_waitcnt lgkmcnt(0)
    s_cmp_eq_u32 s43, 32
    s_cbranch_scc1 SQ16_OK
    s_sub_u32 s58, s58, 1
    s_cmp_lg_u32 s58, 0
    s_cbranch_scc1 SQ16_L
    s_endpgm
CODE_END:
SLOWATT:
    v_mov_b32 v208, 0
    v_mov_b32 v209, 0
    v_mov_b32 v210, 0
    v_mov_b32 v211, 0
    v_mov_b32 v212, 0
    v_mov_b32 v213, 0
    v_mov_b32 v214, 0
    v_mov_b32 v215, 0
    v_mov_b32 v216, 0
    v_mov_b32 v217, 0
    v_mov_b32 v218, 0
    v_mov_b32 v219, 0
    v_mov_b32 v220, 0
    v_mov_b32 v221, 0
    v_mov_b32 v222, 0
    v_mov_b32 v223, 0
    v_mov_b32 v20, 0xf149f2ca
    v_mov_b32 v21, 0xf149f2ca
    v_mfma_f32_32x32x16_bf16 v[80:95], a[164:167], v[16:19], v[224:239]
    v_mfma_f32_32x32x16_bf16 v[96:111], a[160:163], v[16:19], v[208:223]
    v_mfma_f32_32x32x16_bf16 v[64:79], a[160:163], v[12:15], v[224:239]
    s_nop 9
    v_max3_f32 v21, v80, v81, v21
    v_max3_f32 v21, v82, v83, v21
    v_max3_f32 v21, v84, v85, v21
    v_max3_f32 v21, v86, v87, v21
    v_max3_f32 v21, v88, v89, v21
    v_max3_f32 v21, v90, v91, v21
    v_max3_f32 v21, v92, v93, v21
    v_max3_f32 v21, v94, v95, v21
    s_cmp_eq_u32 s49, 0
    s_cbranch_scc1 SW8
SW8_R:
    v_mfma_f32_32x32x16_bf16 v[80:95], a[156:159], v[16:19], v[208:223]
    v_max3_f32 v21, v96, v97, v21
    v_max3_f32 v21, v98, v99, v21
    v_max3_f32 v21, v100, v101, v21
    v_max3_f32 v21, v102, v103, v21
    v_max3_f32 v21, v104, v105, v21
    v_max3_f32 v21, v106, v107, v21
    v_max3_f32 v21, v108, v109, v21
    v_max3_f32 v21, v110, v111, v21
    v_mfma_f32_32x32x16_bf16 v[96:111], a[156:159], v[12:15], v[208:223]
    v_max3_f32 v20, v64, v65, v20
    v_max3_f32 v20, v66, v67, v20
    v_max3_f32 v20, v68, v69, v20
    v_max3_f32 v20, v70, v71, v20
    v_max3_f32 v20, v72, v73, v20
    v_max3_f32 v20, v74, v75, v20
    v_max3_f32 v20, v76, v77, v20
    v_max3_f32 v20, v78, v79, v20
    v_mfma_f32_32x32x16_bf16 v[64:79], a[152:155], v[16:19], v[208:223]
    v_max3_f32 v21, v80, v81, v21
    v_max3_f32 v21, v82, v83, v21
    v_max3_f32 v21, v84, v85, v21
    v_max3_f32 v21, v86, v87, v21
    v_max3_f32 v21, v88, v89, v21
    v_max3_f32 v21, v90, v91, v21
    v_max3_f32 v21, v92, v93, v21
    v_max3_f32 v21, v94, v95, v21
    v_mfma_f32_32x32x16_bf16 v[80:95], a[152:155], v[12:15], v[208:223]
    v_max3_f32 v20, v96, v97, v20
    v_max3_f32 v20, v98, v99, v20
    v_max3_f32 v20, v100, v101, v20
    v_max3_f32 v20, v102, v103, v20
    v_max3_f32 v20, v104, v105, v20
    v_max3_f32 v20, v106, v107, v20
    v_max3_f32 v20, v108, v109, v20
    v_max3_f32 v20, v110, v111, v20
    s_cmp_eq_u32 s49, 1
    s_cbranch_scc1 SW9
SW9_R:
    v_mfma_f32_32x32x16_bf16 v[96:111], a[148:151], v[16:19], v[208:223]
    v_max3_f32 v21, v64, v65, v21
    v_max3_f32 v21, v66, v67, v21
    v_max3_f32 v21, v68, v69, v21
    v_max3_f32 v21, v70, v71, v21
    v_max3_f32 v21, v72, v73, v21
    v_max3_f32 v21, v74, v75, v21
    v_max3_f32 v21, v76, v77, v21
    v_max3_f32 v21, v78, v79, v21
    v_mfma_f32_32x32x16_bf16 v[64:79], a[148:151], v[12:15], v[208:223]
    v_max3_f32 v20, v80, v81, v20
    v_max3_f32 v20, v82, v83, v20
    v_max3_f32 v20, v84, v85, v20
    v_max3_f32 v20, v86, v87, v20
    v_max3_f32 v20, v88, v89, v20
    v_max3_f32 v20, v90, v91, v20
    v_max3_f32 v20, v92, v93, v20
    v_max3_f32 v20, v94, v95, v20
    v_mfma_f32_32x32x16_bf16 v[80:95], a[144:147], v[16:19], v[208:223]
    v_max3_f32 v21, v96, v97, v21
    v_max3_f32 v21, v98, v99, v21
    v_max3_f32 v21, v100, v101, v21
    v_max3_f32 v21, v102, v103, v21
    v_max3_f32 v21, v104, v105, v21
    v_max3_f32 v21, v106, v107, v21
    v_max3_f32 v21, v108, v109, v21
    v_max3_f32 v21, v110, v111, v21
    v_mfma_f32_32x32x16_bf16 v[96:111], a[144:147], v[12:15], v[208:223]
    v_max3_f32 v20, v64, v65, v20
    v_max3_f32 v20, v66, v67, v20
    v_max3_f32 v20, v68, v69, v20
    v_max3_f32 v20, v70, v71, v20
    v_max3_f32 v20, v72, v73, v20
    v_max3_f32 v20, v74, v75, v20
    v_max3_f32 v20, v76, v77, v20
    v_max3_f32 v20, v78, v79, v20
    s_cmp_eq_u32 s49, 2
    s_cbranch_scc1 SW10
SW10_R:
    v_mfma_f32_32x32x16_bf16 v[64:79], a[140:143], v[16:19], v[208:223]
    v_max3_f32 v21, v80, v81, v21
    v_max3_f32 v21, v82, v83, v21
    v_max3_f32 v21, v84, v85, v21
    v_max3_f32 v21, v86, v87, v21
    v_max3_f32 v21, v88, v89, v21
    v_max3_f32 v21, v90, v91, v21
    v_max3_f32 v21, v92, v93, v21
    v_max3_f32 v21, v94, v95, v21
    v_mfma_f32_32x32x16_bf16 v[80:95], a[140:143], v[12:15], v[208:223]
    v_max3_f32 v20, v96, v97, v20
    v_max3_f32 v20, v98, v99, v20
    v_max3_f32 v20, v100, v101, v20
    v_max3_f32 v20, v102, v103, v20
    v_max3_f32 v20, v104, v105, v20
    v_max3_f32 v20, v106, v107, v20
    v_max3_f32 v20, v108, v109, v20
    v_max3_f32 v20, v110, v111, v20
    v_mfma_f32_32x32x16_bf16 v[96:111], a[136:139], v[16:19], v[208:223]
    v_max3_f32 v21, v64, v65, v21
    v_max3_f32 v21, v66, v67, v21
    v_max3_f32 v21, v68, v69, v21
    v_max3_f32 v21, v70, v71, v21
    v_max3_f32 v21, v72, v73, v21
    v_max3_f32 v21, v74, v75, v21
    v_max3_f32 v21, v76, v77, v21
    v_max3_f32 v21, v78, v79, v21
    v_mfma_f32_32x32x16_bf16 v[64:79], a[136:139], v[12:15], v[208:223]
    v_max3_f32 v20, v80, v81, v20
    v_max3_f32 v20, v82, v83, v20
    v_max3_f32 v20, v84, v85, v20
    v_max3_f32 v20, v86, v87, v20
    v_max3_f32 v20, v88, v89, v20
    v_max3_f32 v20, v90, v91, v20
    v_max3_f32 v20, v92, v93, v20
    v_max3_f32 v20, v94, v95, v20
    s_cmp_eq_u32 s49, 3
    s_cbranch_scc1 SW11
SW11_R:
    v_mfma_f32_32x32x16_bf16 v[80:95], a[132:135], v[16:19], v[240:255]
    v_max3_f32 v21, v96, v97, v21
    v_max3_f32 v21, v98, v99, v21
    v_max3_f32 v21, v100, v101, v21
    v_max3_f32 v21, v102, v103, v21
    v_max3_f32 v21, v104, v105, v21
    v_max3_f32 v21, v106, v107, v21
    v_max3_f32 v21, v108, v109, v21
    v_max3_f32 v21, v110, v111, v21
    v_mfma_f32_32x32x16_bf16 v[96:111], a[132:135], v[12:15], v[208:223]
    v_max3_f32 v20, v64, v65, v20
    v_max3_f32 v20, v66, v67, v20
    v_max3_f32 v20, v68, v69, v20
    v_max3_f32 v20, v70, v71, v20
    v_max3_f32 v20, v72, v73, v20
    v_max3_f32 v20, v74, v75, v20
    v_max3_f32 v20, v76, v77, v20
    v_max3_f32 v20, v78, v79, v20
    v_mfma_f32_32x32x16_bf16 v[64:79], a[128:131], v[12:15], v[240:255]
    v_max3_f32 v21, v80, v81, v21
    v_max3_f32 v21, v82, v83, v21
    v_max3_f32 v21, v84, v85, v21
    v_max3_f32 v21, v86, v87, v21
    v_max3_f32 v21, v88, v89, v21
    v_max3_f32 v21, v90, v91, v21
    v_max3_f32 v21, v92, v93, v21
    v_max3_f32 v21, v94, v95, v21
    v_max3_f32 v20, v96, v97, v20
    v_max3_f32 v20, v98, v99, v20
    v_max3_f32 v20, v100, v101, v20
    v_max3_f32 v20, v102, v103, v20
    v_max3_f32 v20, v104, v105, v20
    v_max3_f32 v20, v106, v107, v20
    v_max3_f32 v20, v108, v109, v20
    v_max3_f32 v20, v110, v111, v20
    v_max3_f32 v20, v64, v65, v20
    v_max3_f32 v20, v66, v67, v20
    v_max3_f32 v20, v68, v69, v20
    v_max3_f32 v20, v70, v71, v20
    v_max3_f32 v20, v72, v73, v20
    v_max3_f32 v20, v74, v75, v20
    v_max3_f32 v20, v76, v77, v20
    v_max3_f32 v20, v78, v79, v20
    v_mov_b32_e64 v22, v20
    v_mov_b32 v23, v21
    s_nop 0
    v_permlane32_swap_b32 v20, v22
    v_permlane32_swap_b32 v21, v23
    v_max_f32 v21, v21, v23
    v_max_f32 v20, v20, v22
    v_sub_f32 v128, 0, v21
    v_sub_f32 v129, 0, v21
    v_pk_mov_b32 v[130:131], v[128:129], v[128:129]
    v_pk_mov_b32 v[132:133], v[128:129], v[128:129]
    v_pk_mov_b32 v[134:135], v[128:129], v[128:129]
    v_pk_mov_b32 v[136:137], v[128:129], v[128:129]
    v_pk_mov_b32 v[138:139], v[128:129], v[128:129]
    v_pk_mov_b32 v[140:141], v[128:129], v[128:129]
    v_pk_mov_b32 v[142:143], v[128:129], v[128:129]
    v_sub_f32 v112, 0, v20
    v_sub_f32 v113, 0, v20
    v_pk_mov_b32 v[114:115], v[112:113], v[112:113]
    v_pk_mov_b32 v[116:117], v[112:113], v[112:113]
    v_pk_mov_b32 v[118:119], v[112:113], v[112:113]
    v_pk_mov_b32 v[120:121], v[112:113], v[112:113]
    v_pk_mov_b32 v[122:123], v[112:113], v[112:113]
    v_pk_mov_b32 v[124:125], v[112:113], v[112:113]
    v_pk_mov_b32 v[126:127], v[112:113], v[112:113]
    v_pk_add_f32 v[80:81], v[224:225], v[128:129]
    v_pk_add_f32 v[82:83], v[226:227], v[128:129]
    v_pk_add_f32 v[84:85], v[228:229], v[128:129]
    v_pk_add_f32 v[86:87], v[230:231], v[128:129]
    v_pk_add_f32 v[88:89], v[232:233], v[128:129]
    v_pk_add_f32 v[90:91], v[234:235], v[128:129]
    v_pk_add_f32 v[92:93], v[236:237], v[128:129]
    v_pk_add_f32 v[94:95], v[238:239], v[128:129]
    s_nop 1
    s_nop 0
    v_mfma_f32_32x32x16_bf16 v[80:95], a[164:167], v[16:19], v[80:95]
    v_mfma_f32_32x32x16_bf16 v[96:111], a[160:163], v[16:19], v[128:143]
    v_pk_add_f32 v[64:65], v[224:225], v[112:113]
    v_pk_add_f32 v[66:67], v[226:227], v[112:113]
    v_pk_add_f32 v[68:69], v[228:229], v[112:113]
    v_pk_add_f32 v[70:71], v[230:231], v[112:113]
    v_pk_add_f32 v[72:73], v[232:233], v[112:113]
    v_pk_add_f32 v[74:75], v[234:235], v[112:113]
    v_pk_add_f32 v[76:77], v[236:237], v[112:113]
    v_pk_add_f32 v[78:79], v[238:239], v[112:113]
    s_nop 2
    v_exp_f32 v80, v80
    v_exp_f32_e64 v81, v81
    v_exp_f32 v82, v82
    v_exp_f32 v83, v83
    v_exp_f32 v84, v84
    v_exp_f32 v85, v85
    v_mfma_f32_32x32x16_bf16 v[64:79], a[160:163], v[12:15], v[64:79]
    v_exp_f32 v86, v86
    v_exp_f32 v87, v87
    v_cvt_pk_bf16_f32 v2, v80, v81
    v_cvt_pk_bf16_f32 v3, v82, v83
    v_cvt_pk_bf16_f32 v4, v84, v85
    v_cvt_pk_bf16_f32 v5, v86, v87
    v_exp_f32 v88, v88
    v_exp_f32 v89, v89
    v_mfma_f32_32x32x16_bf16 v[160:175], a[240:243], v[2:5], 0
    v_exp_f32 v90, v90
    v_exp_f32 v91, v91
    v_exp_f32 v92, v92
    v_exp_f32 v93, v93
    v_exp_f32 v94, v94
    v_exp_f32 v95, v95
    v_cvt_pk_bf16_f32 v6, v88, v89
    v_cvt_pk_bf16_f32 v7, v90, v91
    v_cvt_pk_bf16_f32 v8, v92, v93
    v_cvt_pk_bf16_f32 v9, v94, v95
    v_exp_f32 v96, v96
    v_exp_f32 v97, v97
    v_mfma_f32_32x32x16_bf16 v[160:175], a[244:247], v[6:9], v[160:175]
    v_exp_f32 v98, v98
    v_exp_f32 v99, v99
    v_exp_f32 v100, v100
    v_exp_f32 v101, v101
    s_cmp_eq_u32 s49, 0
    s_cbranch_scc1 SW12
SW12_R:
    v_mfma_f32_32x32x16_bf16 v[80:95], a[156:159], v[16:19], v[128:143]
    v_exp_f32 v102, v102
    v_exp_f32 v103, v103
    v_cvt_pk_bf16_f32 v2, v96, v97
    v_cvt_pk_bf16_f32 v3, v98, v99
    v_cvt_pk_bf16_f32 v4, v100, v101
    v_cvt_pk_bf16_f32 v5, v102, v103
    v_exp_f32 v104, v104
    v_exp_f32 v105, v105
    v_mfma_f32_32x32x16_bf16 v[160:175], a[232:235], v[2:5], v[160:175]
    v_exp_f32 v106, v106
    v_exp_f32 v107, v107
    v_exp_f32 v108, v108
    v_exp_f32 v109, v109
    v_exp_f32 v110, v110
    v_exp_f32 v111, v111
    v_cvt_pk_bf16_f32 v6, v104, v105
    v_cvt_pk_bf16_f32 v7, v106, v107
    v_cvt_pk_bf16_f32 v8, v108, v109
    v_cvt_pk_bf16_f32 v9, v110, v111
    v_exp_f32 v64, v64
    v_exp_f32 v65, v65
    v_mfma_f32_32x32x16_bf16 v[160:175], a[236:239], v[6:9], v[160:175]
    v_exp_f32 v66, v66
    v_exp_f32 v67, v67
    v_exp_f32 v68, v68
    v_exp_f32 v69, v69
    v_mfma_f32_32x32x16_bf16 v[96:111], a[156:159], v[12:15], v[112:127]
    v_exp_f32 v70, v70
    v_exp_f32 v71, v71
    v_cvt_pk_bf16_f32 v2, v64, v65
    v_cvt_pk_bf16_f32 v3, v66, v67
    v_cvt_pk_bf16_f32 v4, v68, v69
    v_cvt_pk_bf16_f32 v5, v70, v71
    v_exp_f32 v72, v72
    v_exp_f32 v73, v73
    v_mfma_f32_32x32x16_bf16 v[144:159], a[232:235], v[2:5], 0
    v_exp_f32 v74, v74
    v_exp_f32 v75, v75
    v_exp_f32 v76, v76
    v_exp_f32 v77, v77
    v_exp_f32 v78, v78
    v_exp_f32 v79, v79
    v_cvt_pk_bf16_f32 v6, v72, v73
    v_cvt_pk_bf16_f32 v7, v74, v75
    v_cvt_pk_bf16_f32 v8, v76, v77
    v_cvt_pk_bf16_f32 v9, v78, v79
    v_exp_f32 v80, v80
    v_exp_f32 v81, v81
    v_mfma_f32_32x32x16_bf16 v[144:159], a[236:239], v[6:9], v[144:159]
    v_exp_f32 v82, v82
    v_exp_f32 v83, v83
    v_exp_f32 v84, v84
    v_exp_f32 v85, v85
    v_mfma_f32_32x32x16_bf16 v[64:79], a[152:155], v[16:19], v[128:143]
    v_exp_f32 v86, v86
    v_exp_f32 v87, v87
    v_cvt_pk_bf16_f32 v2, v80, v81
    v_cvt_pk_bf16_f32 v3, v82, v83
    v_cvt_pk_bf16_f32 v4, v84, v85
    v_cvt_pk_bf16_f32 v5, v86, v87
    v_exp_f32 v88, v88
    v_exp_f32 v89, v89
    v_mfma_f32_32x32x16_bf16 v[160:175], a[224:227], v[2:5], v[160:175]
    v_exp_f32 v90, v90
    v_exp_f32 v91, v91
    v_exp_f32 v92, v92
    v_exp_f32 v93, v93
    v_exp_f32 v94, v94
    v_exp_f32 v95, v95
    v_cvt_pk_bf16_f32 v6, v88, v89
    v_cvt_pk_bf16_f32 v7, v90, v91
    v_cvt_pk_bf16_f32 v8, v92, v93
    v_cvt_pk_bf16_f32 v9, v94, v95
    v_exp_f32 v96, v96
    v_exp_f32 v97, v97
    v_mfma_f32_32x32x16_bf16 v[160:175], a[228:231], v[6:9], v[160:175]
    v_exp_f32 v98, v98
    v_exp_f32 v99, v99
    v_exp_f32 v100, v100
    v_exp_f32 v101, v101
    v_mfma_f32_32x32x16_bf16 v[80:95], a[152:155], v[12:15], v[112:127]
    v_exp_f32 v102, v102
    v_exp_f32 v103, v103
    v_cvt_pk_bf16_f32 v2, v96, v97
    v_cvt_pk_bf16_f32 v3, v98, v99
    v_cvt_pk_bf16_f32 v4, v100, v101
    v_cvt_pk_bf16_f32 v5, v102, v103
    v_exp_f32 v104, v104
    v_exp_f32 v105, v105
    v_mfma_f32_32x32x16_bf16 v[144:159], a[224:227], v[2:5], v[144:159]
    v_exp_f32 v106, v106
    v_exp_f32 v107, v107
    v_exp_f32 v108, v108
    v_exp_f32 v109, v109
    v_exp_f32 v110, v110
    v_exp_f32 v111, v111
    v_cvt_pk_bf16_f32 v6, v104, v105
    v_cvt_pk_bf16_f32 v7, v106, v107
    v_cvt_pk_bf16_f32 v8, v108, v109
    v_cvt_pk_bf16_f32 v9, v110, v111
    v_exp_f32 v64, v64
    v_exp_f32 v65, v65
    v_mfma_f32_32x32x16_bf16 v[144:159], a[228:231], v[6:9], v[144:159]
    v_exp_f32 v66, v66
    v_exp_f32 v67, v67
    v_exp_f32 v68, v68
    v_exp_f32 v69, v69
    s_cmp_eq_u32 s49, 1
    s_cbranch_scc1 SW13
SW13_R:
    v_mfma_f32_32x32x16_bf16 v[96:111], a[148:151], v[16:19], v[128:143]
    v_exp_f32 v70, v70
    v_exp_f32 v71, v71
    v_cvt_pk_bf16_f32 v2, v64, v65
    v_cvt_pk_bf16_f32 v3, v66, v67
    v_cvt_pk_bf16_f32 v4, v68, v69
    v_cvt_pk_bf16_f32 v5, v70, v71
    v_exp_f32 v72, v72
    v_exp_f32 v73, v73
    v_mfma_f32_32x32x16_bf16 v[160:175], a[216:219], v[2:5], v[160:175]
    v_exp_f32 v74, v74
    v_exp_f32 v75, v75
    v_exp_f32 v76, v76
    v_exp_f32 v77, v77
    v_exp_f32 v78, v78
    v_exp_f32 v79, v79
    v_cvt_pk_bf16_f32 v6, v72, v73
    v_cvt_pk_bf16_f32 v7, v74, v75
    v_cvt_pk_bf16_f32 v8, v76, v77
    v_cvt_pk_bf16_f32 v9, v78, v79
    v_exp_f32 v80, v80
    v_exp_f32 v81, v81
    v_mfma_f32_32x32x16_bf16 v[160:175], a[220:223], v[6:9], v[160:175]
    v_exp_f32 v82, v82
    v_exp_f32 v83, v83
    v_exp_f32 v84, v84
    v_exp_f32 v85, v85
    v_mfma_f32_32x32x16_bf16 v[64:79], a[148:151], v[12:15], v[112:127]
    v_exp_f32 v86, v86
    v_exp_f32 v87, v87
    v_cvt_pk_bf16_f32 v2, v80, v81
    v_cvt_pk_bf16_f32 v3, v82, v83
    v_cvt_pk_bf16_f32 v4, v84, v85
    v_cvt_pk_bf16_f32 v5, v86, v87
    v_exp_f32 v88, v88
    v_exp_f32 v89, v89
    v_mfma_f32_32x32x16_bf16 v[144:159], a[216:219], v[2:5], v[144:159]
    v_exp_f32 v90, v90
    v_exp_f32 v91, v91
    v_exp_f32 v92, v92
    v_exp_f32 v93, v93
    v_exp_f32 v94, v94
    v_exp_f32 v95, v95
    v_cvt_pk_bf16_f32 v6, v88, v89
    v_cvt_pk_bf16_f32 v7, v90, v91
    v_cvt_pk_bf16_f32 v8, v92, v93
    v_cvt_pk_bf16_f32 v9, v94, v95
    v_exp_f32 v96, v96
    v_exp_f32 v97, v97
    v_mfma_f32_32x32x16_bf16 v[144:159], a[220:223], v[6:9], v[144:159]
    v_exp_f32 v98, v98
    v_exp_f32 v99, v99
    v_exp_f32 v100, v100
    v_exp_f32 v101, v101
    v_mfma_f32_32x32x16_bf16 v[80:95], a[144:147], v[16:19], v[128:143]
    v_exp_f32 v102, v102
    v_exp_f32 v103, v103
    v_cvt_pk_bf16_f32 v2, v96, v97
    v_cvt_pk_bf16_f32 v3, v98, v99
    v_cvt_pk_bf16_f32 v4, v100, v101
    v_cvt_pk_bf16_f32 v5, v102, v103
    v_exp_f32 v104, v104
    v_exp_f32 v105, v105
    v_mfma_f32_32x32x16_bf16 v[160:175], a[208:211], v[2:5], v[160:175]
    v_exp_f32 v106, v106
    v_exp_f32 v107, v107
    v_exp_f32 v108, v108
    v_exp_f32 v109, v109
    v_exp_f32 v110, v110
    v_exp_f32 v111, v111
    v_cvt_pk_bf16_f32 v6, v104, v105
    v_cvt_pk_bf16_f32 v7, v106, v107
    v_cvt_pk_bf16_f32 v8, v108, v109
    v_cvt_pk_bf16_f32 v9, v110, v111
    v_exp_f32 v64, v64
    v_exp_f32 v65, v65
    v_mfma_f32_32x32x16_bf16 v[160:175], a[212:215], v[6:9], v[160:175]
    v_exp_f32 v66, v66
    v_exp_f32 v67, v67
    v_exp_f32 v68, v68
    v_exp_f32 v69, v69
    v_mfma_f32_32x32x16_bf16 v[96:111], a[144:147], v[12:15], v[112:127]
    v_exp_f32 v70, v70
    v_exp_f32 v71, v71
    v_cvt_pk_bf16_f32 v2, v64, v65
    v_cvt_pk_bf16_f32 v3, v66, v67
    v_cvt_pk_bf16_f32 v4, v68, v69
    v_cvt_pk_bf16_f32 v5, v70, v71
    v_exp_f32 v72, v72
    v_exp_f32 v73, v73
    v_mfma_f32_32x32x16_bf16 v[144:159], a[208:211], v[2:5], v[144:159]
    v_exp_f32 v74, v74
    v_exp_f32 v75, v75
    v_exp_f32 v76, v76
    v_exp_f32 v77, v77
    v_exp_f32 v78, v78
    v_exp_f32 v79, v79
    v_cvt_pk_bf16_f32 v6, v72, v73
    v_cvt_pk_bf16_f32 v7, v74, v75
    v_cvt_pk_bf16_f32 v8, v76, v77
    v_cvt_pk_bf16_f32 v9, v78, v79
    v_exp_f32 v80, v80
    v_exp_f32 v81, v81
    v_mfma_f32_32x32x16_bf16 v[144:159], a[212:215], v[6:9], v[144:159]
    v_exp_f32 v82, v82
    v_exp_f32 v83, v83
    v_exp_f32 v84, v84
    v_exp_f32 v85, v85
    s_cmp_eq_u32 s49, 2
    s_cbranch_scc1 SW14
SW14_R:
    v_mfma_f32_32x32x16_bf16 v[64:79], a[140:143], v[16:19], v[128:143]
    v_exp_f32 v86, v86
    v_exp_f32 v87, v87
    v_cvt_pk_bf16_f32 v2, v80, v81
    v_cvt_pk_bf16_f32 v3, v82, v83
    v_cvt_pk_bf16_f32 v4, v84, v85
    v_cvt_pk_bf16_f32 v5, v86, v87
    v_exp_f32 v88, v88
    v_exp_f32 v89, v89
    v_mfma_f32_32x32x16_bf16 v[160:175], a[200:203], v[2:5], v[160:175]
    v_exp_f32 v90, v90
    v_exp_f32 v91, v91
    v_exp_f32 v92, v92
    v_exp_f32 v93, v93
    v_exp_f32 v94, v94
    v_exp_f32 v95, v95
    v_cvt_pk_bf16_f32 v6, v88, v89
    v_cvt_pk_bf16_f32 v7, v90, v91
    v_cvt_pk_bf16_f32 v8, v92, v93
    v_cvt_pk_bf16_f32 v9, v94, v95
    v_exp_f32 v96, v96
    v_exp_f32 v97, v97
    v_mfma_f32_32x32x16_bf16 v[160:175], a[204:207], v[6:9], v[160:175]
    v_exp_f32 v98, v98
    v_exp_f32 v99, v99
    v_exp_f32 v100, v100
    v_exp_f32 v101, v101
    v_mfma_f32_32x32x16_bf16 v[80:95], a[140:143], v[12:15], v[112:127]
    v_exp_f32 v102, v102
    v_exp_f32 v103, v103
    v_cvt_pk_bf16_f32 v2, v96, v97
    v_cvt_pk_bf16_f32 v3, v98, v99
    v_cvt_pk_bf16_f32 v4, v100, v101
    v_cvt_pk_bf16_f32 v5, v102, v103
    v_exp_f32 v104, v104
    v_exp_f32 v105, v105
    v_mfma_f32_32x32x16_bf16 v[144:159], a[200:203], v[2:5], v[144:159]
    v_exp_f32 v106, v106
    v_exp_f32 v107, v107
    v_exp_f32 v108, v108
    v_exp_f32 v109, v109
    v_exp_f32 v110, v110
    v_exp_f32 v111, v111
    v_cvt_pk_bf16_f32 v6, v104, v105
    v_cvt_pk_bf16_f32 v7, v106, v107
    v_cvt_pk_bf16_f32 v8, v108, v109
    v_cvt_pk_bf16_f32 v9, v110, v111
    v_exp_f32 v64, v64
    v_exp_f32 v65, v65
    v_mfma_f32_32x32x16_bf16 v[144:159], a[204:207], v[6:9], v[144:159]
    v_exp_f32 v66, v66
    v_exp_f32 v67, v67
    v_exp_f32 v68, v68
    v_exp_f32 v69, v69
    v_mfma_f32_32x32x16_bf16 v[96:111], a[136:139], v[16:19], v[128:143]
    v_exp_f32 v70, v70
    v_exp_f32 v71, v71
    v_cvt_pk_bf16_f32 v2, v64, v65
    v_cvt_pk_bf16_f32 v3, v66, v67
    v_cvt_pk_bf16_f32 v4, v68, v69
    v_cvt_pk_bf16_f32 v5, v70, v71
    v_exp_f32 v72, v72
    v_exp_f32 v73, v73
    v_mfma_f32_32x32x16_bf16 v[160:175], a[192:195], v[2:5], v[160:175]
    v_exp_f32 v74, v74
    v_exp_f32 v75, v75
    v_exp_f32 v76, v76
    v_exp_f32 v77, v77
    v_exp_f32 v78, v78
    v_exp_f32 v79, v79
    v_cvt_pk_bf16_f32 v6, v72, v73
    v_cvt_pk_bf16_f32 v7, v74, v75
    v_cvt_pk_bf16_f32 v8, v76, v77
    v_cvt_pk_bf16_f32 v9, v78, v79
    v_exp_f32 v80, v80
    v_exp_f32 v81, v81
    v_mfma_f32_32x32x16_bf16 v[160:175], a[196:199], v[6:9], v[160:175]
    v_exp_f32 v82, v82
    v_exp_f32 v83, v83
    v_exp_f32 v84, v84
    v_exp_f32 v85, v85
    v_mfma_f32_32x32x16_bf16 v[64:79], a[136:139], v[12:15], v[112:127]
    v_exp_f32 v86, v86
    v_exp_f32 v87, v87
    v_cvt_pk_bf16_f32 v2, v80, v81
    v_cvt_pk_bf16_f32 v3, v82, v83
    v_cvt_pk_bf16_f32 v4, v84, v85
    v_cvt_pk_bf16_f32 v5, v86, v87
    v_exp_f32 v88, v88
    v_exp_f32 v89, v89
    v_mfma_f32_32x32x16_bf16 v[144:159], a[192:195], v[2:5], v[144:159]
    v_exp_f32 v90, v90
    v_exp_f32 v91, v91
    v_exp_f32 v92, v92
    v_exp_f32 v93, v93
    v_exp_f32 v94, v94
    v_exp_f32 v95, v95
    v_cvt_pk_bf16_f32 v6, v88, v89
    v_cvt_pk_bf16_f32 v7, v90, v91
    v_cvt_pk_bf16_f32 v8, v92, v93
    v_cvt_pk_bf16_f32 v9, v94, v95
    v_pk_add_f32 v[80:81], v[240:241], v[128:129]
    v_pk_add_f32 v[82:83], v[242:243], v[128:129]
    v_pk_add_f32 v[84:85], v[244:245], v[128:129]
    v_pk_add_f32 v[86:87], v[246:247], v[128:129]
    v_pk_add_f32 v[88:89], v[248:249], v[128:129]
    v_pk_add_f32 v[90:91], v[250:251], v[128:129]
    v_pk_add_f32 v[92:93], v[252:253], v[128:129]
    v_pk_add_f32 v[94:95], v[254:255], v[128:129]
    v_exp_f32 v96, v96
    v_exp_f32 v97, v97
    v_mfma_f32_32x32x16_bf16 v[144:159], a[196:199], v[6:9], v[144:159]
    v_exp_f32 v98, v98
    v_exp_f32 v99, v99
    v_exp_f32 v100, v100
    v_exp_f32 v101, v101
    s_cmp_eq_u32 s49, 3
    s_cbranch_scc1 SW15
SW15_R:
    v_mfma_f32_32x32x16_bf16 v[80:95], a[132:135], v[16:19], v[80:95]
    v_exp_f32 v102, v102
    v_exp_f32 v103, v103
    v_cvt_pk_bf16_f32 v2, v96, v97
    v_cvt_pk_bf16_f32 v3, v98, v99
    v_cvt_pk_bf16_f32 v4, v100, v101
    v_cvt_pk_bf16_f32 v5, v102, v103
    v_exp_f32 v104, v104
    v_exp_f32 v105, v105
    v_mfma_f32_32x32x16_bf16 v[160:175], a[184:187], v[2:5], v[160:175]
    v_exp_f32 v106, v106
    v_exp_f32 v107, v107
    v_exp_f32 v108, v108
    v_exp_f32 v109, v109
    v_exp_f32 v110, v110
    v_exp_f32 v111, v111
    v_cvt_pk_bf16_f32 v6, v104, v105
    v_cvt_pk_bf16_f32 v7, v106, v107
    v_cvt_pk_bf16_f32 v8, v108, v109
    v_cvt_pk_bf16_f32 v9, v110, v111
    v_exp_f32 v64, v64
    v_exp_f32 v65, v65
    v_mfma_f32_32x32x16_bf16 v[160:175], a[188:191], v[6:9], v[160:175]
    v_exp_f32 v66, v66
    v_exp_f32 v67, v67
    v_exp_f32 v68, v68
    v_exp_f32 v69, v69
    v_mfma_f32_32x32x16_bf16 v[96:111], a[132:135], v[12:15], v[112:127]
    v_exp_f32 v70, v70
    v_exp_f32 v71, v71
    v_cvt_pk_bf16_f32 v2, v64, v65
    v_cvt_pk_bf16_f32 v3, v66, v67
    v_cvt_pk_bf16_f32 v4, v68, v69
    v_cvt_pk_bf16_f32 v5, v70, v71
    v_exp_f32 v72, v72
    v_exp_f32 v73, v73
    v_mfma_f32_32x32x16_bf16 v[144:159], a[184:187], v[2:5], v[144:159]
    v_exp_f32 v74, v74
    v_exp_f32 v75, v75
    v_exp_f32 v76, v76
    v_exp_f32 v77, v77
    v_exp_f32 v78, v78
    v_exp_f32 v79, v79
    v_cvt_pk_bf16_f32 v6, v72, v73
    v_cvt_pk_bf16_f32 v7, v74, v75
    v_cvt_pk_bf16_f32 v8, v76, v77
    v_cvt_pk_bf16_f32 v9, v78, v79
    v_pk_add_f32 v[64:65], v[240:241], v[112:113]
    v_pk_add_f32 v[66:67], v[242:243], v[112:113]
    v_pk_add_f32 v[68:69], v[244:245], v[112:113]
    v_pk_add_f32 v[70:71], v[246:247], v[112:113]
    v_pk_add_f32 v[72:73], v[248:249], v[112:113]
    v_pk_add_f32 v[74:75], v[250:251], v[112:113]
    v_pk_add_f32 v[76:77], v[252:253], v[112:113]
    v_pk_add_f32 v[78:79], v[254:255], v[112:113]
    v_exp_f32 v80, v80
    v_exp_f32 v81, v81
    v_mfma_f32_32x32x16_bf16 v[144:159], a[188:191], v[6:9], v[144:159]
    v_exp_f32 v82, v82
    v_exp_f32 v83, v83
    v_exp_f32 v84, v84
    v_exp_f32 v85, v85
    v_mfma_f32_32x32x16_bf16 v[64:79], a[128:131], v[12:15], v[64:79]
    v_exp_f32 v86, v86
    v_exp_f32 v87, v87
    v_cvt_pk_bf16_f32 v2, v80, v81
    v_cvt_pk_bf16_f32 v3, v82, v83
    v_cvt_pk_bf16_f32 v4, v84, v85
    v_cvt_pk_bf16_f32 v5, v86, v87
    v_exp_f32 v88, v88
    v_exp_f32 v89, v89
    v_mfma_f32_32x32x16_bf16 v[160:175], a[176:179], v[2:5], v[160:175]
    v_exp_f32 v90, v90
    v_exp_f32 v91, v91
    v_exp_f32 v92, v92
    v_exp_f32 v93, v93
    v_exp_f32 v94, v94
    v_exp_f32 v95, v95
    v_cvt_pk_bf16_f32 v6, v88, v89
    v_cvt_pk_bf16_f32 v7, v90, v91
    v_cvt_pk_bf16_f32 v8, v92, v93
    v_cvt_pk_bf16_f32 v9, v94, v95
    v_exp_f32 v96, v96
    v_exp_f32 v97, v97
    v_mfma_f32_32x32x16_bf16 v[160:175], a[180:183], v[6:9], v[160:175]
    v_exp_f32 v98, v98
    v_exp_f32 v99, v99
    v_exp_f32 v100, v100
    v_exp_f32 v101, v101
    v_exp_f32 v102, v102
    v_exp_f32 v103, v103
    v_cvt_pk_bf16_f32 v2, v96, v97
    v_cvt_pk_bf16_f32 v3, v98, v99
    v_cvt_pk_bf16_f32 v4, v100, v101
    v_cvt_pk_bf16_f32 v5, v102, v103
    v_exp_f32 v104, v104
    v_exp_f32 v105, v105
    v_mfma_f32_32x32x16_bf16 v[144:159], a[176:179], v[2:5], v[144:159]
    v_exp_f32 v106, v106
    v_exp_f32 v107, v107
    v_exp_f32 v108, v108
    v_exp_f32 v109, v109
    v_exp_f32 v110, v110
    v_exp_f32 v111, v111
    v_cvt_pk_bf16_f32 v6, v104, v105
    v_cvt_pk_bf16_f32 v7, v106, v107
    v_cvt_pk_bf16_f32 v8, v108, v109
    v_cvt_pk_bf16_f32 v9, v110, v111
    v_exp_f32 v64, v64
    v_exp_f32 v65, v65
    v_mfma_f32_32x32x16_bf16 v[144:159], a[180:183], v[6:9], v[144:159]
    v_exp_f32 v66, v66
    v_exp_f32 v67, v67
    v_exp_f32 v68, v68
    v_exp_f32 v69, v69
    v_exp_f32 v70, v70
    v_exp_f32 v71, v71
    v_cvt_pk_bf16_f32 v2, v64, v65
    v_cvt_pk_bf16_f32 v3, v66, v67
    v_cvt_pk_bf16_f32 v4, v68, v69
    v_cvt_pk_bf16_f32 v5, v70, v71
    v_exp_f32 v72, v72
    v_exp_f32 v73, v73
    v_mfma_f32_32x32x16_bf16 v[144:159], a[168:171], v[2:5], v[144:159]
    v_exp_f32 v74, v74
    v_exp_f32 v75, v75
    v_exp_f32 v76, v76
    v_exp_f32 v77, v77
    v_exp_f32 v78, v78
    v_exp_f32 v79, v79
    v_cvt_pk_bf16_f32 v6, v72, v73
    v_cvt_pk_bf16_f32 v7, v74, v75
    v_cvt_pk_bf16_f32 v8, v76, v77
    v_cvt_pk_bf16_f32 v9, v78, v79
    s_nop 1
    v_mfma_f32_32x32x16_bf16 v[144:159], a[172:175], v[6:9], v[144:159]
    s_branch ATT_DONE
.set CODE_BYTES, CODE_END - gated_mix__sliding_block__dense_activation_mish__prompt_kernel - 128
.section .rodata,"a"
.p2align 6
.amdhsa_kernel gated_mix__sliding_block__dense_activation_mish__prompt_kernel
  .amdhsa_next_free_vgpr 512
  .amdhsa_next_free_sgpr 102
  .amdhsa_accum_offset 256
  .amdhsa_group_segment_fixed_size 0
  .amdhsa_kernarg_size 88
  .amdhsa_user_sgpr_count 2
  .amdhsa_user_sgpr_kernarg_segment_ptr 1
  .amdhsa_system_sgpr_workgroup_id_x 1
.end_amdhsa_kernel
```
